```python
import torch

def _softmax(x, axis=-1):
    return torch.softmax(x, dim=axis)
def _gelu(x):
    return torch.nn.functional.gelu(x, approximate="tanh")
def _silu(x):
    return torch.nn.functional.silu(x)
def _sigmoid(x):
    return torch.sigmoid(x)
def _layernorm(x, axis=-1, eps=1e-5):
    m = x.mean(dim=axis, keepdim=True)
    v = x.var(dim=axis, keepdim=True, unbiased=False)
    return (x - m) / torch.sqrt(v + eps)
def _scatter_add(tgt, idx, src, axis=0):
    return tgt.clone().index_add_(axis, idx, src)
def _segment_sum(src, seg, n):
    out = torch.zeros((n,) + src.shape[1:], dtype=src.dtype)
    return out.index_add_(0, seg, src)
def _pad(x, pw):
    flat = tuple(v for pair in reversed(pw) for v in pair)
    return torch.nn.functional.pad(x, flat)

kernel_name = 'concat_heads__sliding_block__grouped_kv_mqa__prompt'

def setup_inputs():

    _w = (lambda a: (lambda t: t.to(torch.bfloat16) if t.is_floating_point() else t)(torch.as_tensor(a)))
    def _A_setup():
        B, S, D = 1, 2048, 1024
        return {
            "x": _w((lambda *s: torch.randn(*s, dtype=torch.bfloat16) * 0.2)(B, S, D)),
            "wqkv": _w((lambda *s: torch.randn(*s, dtype=torch.bfloat16) * 0.2)(D, 3 * D)),
            "wo": _w((lambda *s: torch.randn(*s, dtype=torch.bfloat16) * 0.05)(D, D)),
        }
    _A_in = _A_setup()

    def _B_setup():
        B, S, D, H = 1, 2048, 1024, 32
        Dh = D // H
        return {
            "x": _w((lambda *s: torch.randn(*s, dtype=torch.bfloat16) * 0.05)(B, S, D)),
            "wq": _w((lambda *s: torch.randn(*s, dtype=torch.bfloat16) * 0.8)(D, H * Dh)),
            "wk": _w((lambda *s: torch.randn(*s, dtype=torch.bfloat16) * 0.8)(D, Dh)),
            "wv": _w((lambda *s: torch.randn(*s, dtype=torch.bfloat16) * 0.2)(D, Dh)),
            "wo": _w((lambda *s: torch.randn(*s, dtype=torch.bfloat16) * 0.2)(H * Dh, D)),
        }
    _B_in = _B_setup()

    return {
        "A_x": _A_in["x"],
        "A_wqkv": _A_in["wqkv"],
        "A_wo": _A_in["wo"],
        "B_x": _B_in["x"],
        "B_wq": _B_in["wq"],
        "B_wk": _B_in["wk"],
        "B_wv": _B_in["wv"],
        "B_wo": _B_in["wo"],
    }

def reference(A_x, A_wqkv, A_wo, B_x, B_wq, B_wk, B_wv, B_wo):
    def _A_ref(x, wqkv, wo):
        B, S, D = x.shape
        H = 32; Dh = D // H; W = 256
        qkv = (lambda x, *d: x.permute(*d))((x @ wqkv).reshape(B, S, 3, H, Dh), 2, 0, 3, 1, 4)
        q, k, v = qkv[0], qkv[1], qkv[2]
        scores = torch.einsum("bhqd,bhkd->bhqk", q, k) * (Dh ** -0.5)
        idx = torch.arange(S)
        mask = (idx[:, None] - idx[None, :] >= 0) & (idx[:, None] - idx[None, :] < W)
        scores = torch.where(mask[None, None], scores, -1e9)
        p = _softmax(scores, axis=-1)
        o = torch.einsum("bhqk,bhkd->bhqd", p, v)
        return (lambda x, *d: x.permute(*d))(o, 0, 2, 1, 3).reshape(B, S, D) @ wo

    def _B_ref(x, wq, wk, wv, wo):
        B, S, D = x.shape
        H = 32
        Dh = D // H
        q = (lambda x, *d: x.permute(*d))((x @ wq).reshape(B, S, H, Dh), 0, 2, 1, 3)
        k = x @ wk
        v = x @ wv
        scores = torch.einsum("bhqd,bkd->bhqk", q, k) * (Dh ** -0.5)
        p = _softmax(scores, axis=-1)
        o = torch.einsum("bhqk,bkd->bhqd", p, v)
        return (lambda x, *d: x.permute(*d))(o, 0, 2, 1, 3).reshape(B, S, H * Dh) @ wo

    a = _A_ref(A_x, A_wqkv, A_wo)
    b = _B_ref(B_x, B_wq, B_wk, B_wv, B_wo)
    return torch.concatenate([a, b], axis=-1)
```

```asm
; @launch kernel=proj_kernel grid=(256,1,1) block=(512,1,1) lds=159744
; @launch kernel=attn_kernel grid=(256,1,1) block=(512,1,1) lds=163840
; @launch kernel=outp_kernel grid=(256,1,1) block=(512,1,1) lds=163840
.amdgcn_target "amdgcn-amd-amdhsa--gfx950"
.text
.globl proj_kernel
.p2align 8
.type proj_kernel,@function
proj_kernel:
    s_cmp_ge_u32 s2, 256
    s_cbranch_scc1 p1_end
    v_lshrrev_b32 v1, 6, v0
    v_and_b32 v0, 63, v0
    v_readfirstlane_b32 s39, v1
    s_cmp_lt_u32 s39, 4
    s_cbranch_scc1 p1_compute
    s_load_dwordx16 s[4:19], s[0:1], 0
    s_and_b32 s34, s2, 7
    s_lshr_b32 s35, s2, 3
    s_and_b32 s41, s34, 1
    s_lshl_b32 s41, s41, 2
    s_and_b32 s36, s35, 3
    s_add_u32 s36, s36, s41
    s_lshr_b32 s37, s35, 2
    s_lshr_b32 s38, s34, 1
    s_add_u32 s38, s38, 3
    s_and_b32 s38, s38, 3
    s_cmp_eq_u32 s38, 3
    s_mov_b32 s41, 6144
    s_cselect_b32 s40, 2048, s41
    s_mov_b32 s41, 6291456
    s_cselect_b32 s26, 2097152, s41
    s_sub_u32 s39, s39, 4
    s_lshl_b32 s41, s36, 8
    s_lshr_b32 s45, s37, 1
    s_cmp_eq_u32 s38, 3
    s_cselect_b32 s45, s45, 0
    s_and_b32 s69, s45, 1
    s_lshl_b32 s69, s69, 16
    s_xor_b32 s70, s69, 0x10000
    s_and_b32 s45, s45, 2
    s_lshl_b32 s44, s39, 1
    s_xor_b32 s44, s44, s45
    s_lshl_b32 s44, s44, 5
    s_add_u32 s41, s41, s44
    v_lshrrev_b32 v24, 3, v0
    v_add_u32 v24, s41, v24
    v_lshlrev_b32 v24, 11, v24
    v_and_b32 v25, 7, v0
    v_lshrrev_b32 v26, 4, v0
    v_xor_b32 v25, v25, v26
    v_lshl_add_u32 v1, v25, 4, v24
    v_xor_b32 v25, 4, v25
    v_lshl_add_u32 v27, v25, 4, v24
    v_add_u32 v2, 16384, v27
    s_lshl_b32 s41, s39, 4
    v_add_u32 v24, s41, v26
    v_mul_lo_u32 v24, v24, s40
    s_lshl_b32 s41, s38, 11
    s_cmp_eq_u32 s38, 3
    s_cselect_b32 s41, 0, s41
    s_lshl_b32 s44, s37, 8
    s_add_u32 s41, s41, s44
    v_add_u32 v24, s41, v24
    s_lshl_b32 s33, s40, 2
    s_lshl_b32 s44, s40, 3
    v_lshlrev_b32 v26, 2, v26
    v_and_b32 v25, 15, v0
    v_xor_b32 v25, v25, v26
    v_lshl_add_u32 v3, v25, 4, v24
    v_xor_b32 v25, 2, v25
    v_add_u32 v24, s44, v24
    v_lshl_add_u32 v4, v25, 4, v24
    v_lshlrev_b32 v20, 4, v0
    s_lshl_b32 s51, s39, 10
    v_lshrrev_b32 v25, 5, v0
    v_lshlrev_b32 v25, 5, v25
    v_xor_b32 v25, v25, v20
    v_add_u32 v5, s51, v25
    s_add_u32 s51, s51, 49152
    s_lshl_b32 s49, s39, 13
    s_lshl_b32 s50, s39, 12
    s_add_u32 s50, s50, 32768
    s_lshl_b32 s55, s40, 6
    s_add_u32 s41, s36, s37
    s_and_b32 s41, s41, 1
    s_mul_i32 s41, s41, 8
    s_lshl_b32 s52, s41, 7
    s_mul_i32 s53, s41, s55
    s_lshl_b32 s54, s41, 12
    s_lshl_b32 s62, s55, 4
    s_mov_b32 s46, 0
    s_mov_b32 s48, 0
    s_mov_b32 s68, 0
    s_mov_b32 s22, 4194304
    s_mov_b32 s23, 0x00020000
    s_mov_b32 s27, 0x00020000
    s_mov_b32 s30, 65536
    s_mov_b32 s31, 0x00020000
    s_mov_b32 s66, 0x2000000
    s_mov_b32 s67, 0x00020000
    s_waitcnt lgkmcnt(0)
    s_cmp_eq_u32 s38, 3
    s_cselect_b32 s24, s12, s6
    s_cselect_b32 s25, s13, s7
    s_cselect_b32 s20, s10, s4
    s_cselect_b32 s21, s11, s5
    s_bitcmp1_b32 s37, 0
    s_cselect_b32 s28, s16, s14
    s_cselect_b32 s29, s17, s15
    s_load_dwordx2 s[64:65], s[0:1], 80
p1_lloop:
    s_cmp_lt_u32 s48, 2
    s_cbranch_scc1 p1_lissue
    s_waitcnt vmcnt(12)
    s_barrier
p1_lissue:
    s_add_u32 s57, s46, s50
    s_add_u32 s56, s46, s49
    s_add_u32 m0, s57, 0
    s_add_u32 s32, s53, s33
    buffer_load_dwordx4 v3, s[24:27], s53 offen  lds
    s_add_u32 m0, s57, 1024
    s_nop 0
    buffer_load_dwordx4 v3, s[24:27], s32 offen  lds
    s_add_u32 m0, s57, 2048
    s_nop 0
    buffer_load_dwordx4 v4, s[24:27], s53 offen  lds
    s_add_u32 m0, s57, 3072
    s_nop 0
    buffer_load_dwordx4 v4, s[24:27], s32 offen  lds
    s_add_u32 m0, s56, 0
    s_add_u32 s41, s52, s69
    buffer_load_dwordx4 v1, s[20:23], s41 offen  lds
    s_add_u32 m0, s56, 1024
    s_nop 0
    buffer_load_dwordx4 v2, s[20:23], s41 offen  lds
    s_add_u32 m0, s56, 2048
    s_add_u32 s41, s41, 32768
    buffer_load_dwordx4 v1, s[20:23], s41 offen  lds
    s_add_u32 m0, s56, 3072
    s_nop 0
    buffer_load_dwordx4 v2, s[20:23], s41 offen  lds
    s_add_u32 m0, s56, 4096
    s_add_u32 s41, s52, s70
    buffer_load_dwordx4 v1, s[20:23], s41 offen  lds
    s_add_u32 m0, s56, 5120
    s_nop 0
    buffer_load_dwordx4 v2, s[20:23], s41 offen  lds
    s_add_u32 m0, s56, 6144
    s_add_u32 s41, s41, 32768
    buffer_load_dwordx4 v1, s[20:23], s41 offen  lds
    s_add_u32 m0, s56, 7168
    s_nop 0
    buffer_load_dwordx4 v2, s[20:23], s41 offen  lds
    s_cmp_eq_u32 s38, 3
    s_cbranch_scc1 p1_lE
p1_lback:
    s_add_u32 s52, s52, 128
    s_add_u32 s53, s53, s55
    s_and_b32 s52, s52, 2047
    s_cmp_eq_u32 s53, s62
    s_cselect_b32 s53, 0, s53
    s_add_u32 s46, s46, 53248
    s_cmp_eq_u32 s46, 159744
    s_cselect_b32 s46, 0, s46
    s_add_u32 s48, s48, 1
    s_cmp_lt_u32 s48, 16
    s_cbranch_scc1 p1_lloop
    s_waitcnt vmcnt(12)
    s_barrier
    s_waitcnt vmcnt(4)
    s_barrier
    s_waitcnt vmcnt(0)
    s_barrier
    s_endpgm
p1_lE:
    s_add_u32 m0, s46, s51
    s_nop 0
    buffer_load_dwordx4 v5, s[28:31], s54 offen lds
    s_add_u32 s54, s54, 4096
    s_and_b32 s54, s54, 65535
    s_branch p1_lback
p1_compute:
    s_load_dwordx2 s[64:65], s[0:1], 80
    s_and_b32 s34, s2, 7
    s_lshr_b32 s35, s2, 3
    s_and_b32 s41, s34, 1
    s_lshl_b32 s41, s41, 2
    s_and_b32 s36, s35, 3
    s_add_u32 s36, s36, s41
    s_lshr_b32 s37, s35, 2
    s_lshr_b32 s38, s34, 1
    s_add_u32 s38, s38, 3
    s_and_b32 s38, s38, 3
    v_lshrrev_b32 v232, 4, v0
    v_and_b32 v233, 15, v0
    s_cmp_eq_u32 s38, 2
    s_cselect_b64 vcc, -1, 0
    v_lshrrev_b32 v234, 2, v233
    v_and_b32 v235, 1, v234
    v_lshlrev_b32 v235, 1, v235
    v_lshrrev_b32 v236, 1, v234
    v_or_b32 v235, v235, v236
    v_cndmask_b32 v234, v234, v235, vcc
    v_lshlrev_b32 v234, 2, v234
    v_and_b32 v235, 3, v0
    v_or_b32 v234, v234, v235
    v_lshrrev_b32 v235, 1, v234
    s_and_b32 s41, s39, 1
    s_lshl_b32 s41, s41, 14
    v_lshlrev_b32 v234, 7, v234
    v_add_u32 v234, s41, v234
    v_or_b32 v236, 0, v232
    v_xor_b32 v236, v236, v235
    v_lshlrev_b32 v236, 4, v236
    v_add_u32 v224, v234, v236
    v_or_b32 v236, 4, v232
    v_xor_b32 v236, v236, v235
    v_lshlrev_b32 v236, 4, v236
    v_add_u32 v225, v234, v236
    v_lshrrev_b32 v233, 2, v0
    v_and_b32 v233, 3, v233
    v_lshlrev_b32 v234, 3, v232
    v_add_u32 v234, v234, v233
    v_lshlrev_b32 v234, 8, v234
    v_add_u32 v234, 32768, v234
    v_and_b32 v235, 3, v0
    v_and_b32 v236, 1, v235
    v_lshlrev_b32 v236, 1, v236
    v_lshrrev_b32 v226, 1, v235
    v_or_b32 v236, v236, v226
    v_cndmask_b32 v235, v236, v235, vcc
    v_lshlrev_b32 v235, 3, v235
    v_add_u32 v234, v234, v235
    v_lshlrev_b32 v233, 1, v233
    v_and_b32 v232, 1, v232
    v_or_b32 v233, v233, v232
    s_and_b32 s41, s39, 2
    s_lshl_b32 s41, s41, 1
    s_add_u32 s44, s41, 0
    v_xor_b32 v236, s44, v233
    v_lshlrev_b32 v236, 5, v236
    v_add_u32 v226, v234, v236
    s_add_u32 s44, s41, 1
    v_xor_b32 v236, s44, v233
    v_lshlrev_b32 v236, 5, v236
    v_add_u32 v227, v234, v236
    s_add_u32 s44, s41, 2
    v_xor_b32 v236, s44, v233
    v_lshlrev_b32 v236, 5, v236
    v_add_u32 v228, v234, v236
    s_add_u32 s44, s41, 3
    v_xor_b32 v236, s44, v233
    v_lshlrev_b32 v236, 5, v236
    v_add_u32 v229, v234, v236
    v_lshlrev_b32 v230, 4, v0
    v_mov_b32 v0, 0
    v_mov_b32 v1, 0
    v_mov_b32 v2, 0
    v_mov_b32 v3, 0
    v_mov_b32 v4, 0
    v_mov_b32 v5, 0
    v_mov_b32 v6, 0
    v_mov_b32 v7, 0
    v_mov_b32 v8, 0
    v_mov_b32 v9, 0
    v_mov_b32 v10, 0
    v_mov_b32 v11, 0
    v_mov_b32 v12, 0
    v_mov_b32 v13, 0
    v_mov_b32 v14, 0
    v_mov_b32 v15, 0
    v_mov_b32 v16, 0
    v_mov_b32 v17, 0
    v_mov_b32 v18, 0
    v_mov_b32 v19, 0
    v_mov_b32 v20, 0
    v_mov_b32 v21, 0
    v_mov_b32 v22, 0
    v_mov_b32 v23, 0
    v_mov_b32 v24, 0
    v_mov_b32 v25, 0
    v_mov_b32 v26, 0
    v_mov_b32 v27, 0
    v_mov_b32 v28, 0
    v_mov_b32 v29, 0
    v_mov_b32 v30, 0
    v_mov_b32 v31, 0
    v_mov_b32 v32, 0
    v_mov_b32 v33, 0
    v_mov_b32 v34, 0
    v_mov_b32 v35, 0
    v_mov_b32 v36, 0
    v_mov_b32 v37, 0
    v_mov_b32 v38, 0
    v_mov_b32 v39, 0
    v_mov_b32 v40, 0
    v_mov_b32 v41, 0
    v_mov_b32 v42, 0
    v_mov_b32 v43, 0
    v_mov_b32 v44, 0
    v_mov_b32 v45, 0
    v_mov_b32 v46, 0
    v_mov_b32 v47, 0
    v_mov_b32 v48, 0
    v_mov_b32 v49, 0
    v_mov_b32 v50, 0
    v_mov_b32 v51, 0
    v_mov_b32 v52, 0
    v_mov_b32 v53, 0
    v_mov_b32 v54, 0
    v_mov_b32 v55, 0
    v_mov_b32 v56, 0
    v_mov_b32 v57, 0
    v_mov_b32 v58, 0
    v_mov_b32 v59, 0
    v_mov_b32 v60, 0
    v_mov_b32 v61, 0
    v_mov_b32 v62, 0
    v_mov_b32 v63, 0
    v_mov_b32 v64, 0
    v_mov_b32 v65, 0
    v_mov_b32 v66, 0
    v_mov_b32 v67, 0
    v_mov_b32 v68, 0
    v_mov_b32 v69, 0
    v_mov_b32 v70, 0
    v_mov_b32 v71, 0
    v_mov_b32 v72, 0
    v_mov_b32 v73, 0
    v_mov_b32 v74, 0
    v_mov_b32 v75, 0
    v_mov_b32 v76, 0
    v_mov_b32 v77, 0
    v_mov_b32 v78, 0
    v_mov_b32 v79, 0
    v_mov_b32 v80, 0
    v_mov_b32 v81, 0
    v_mov_b32 v82, 0
    v_mov_b32 v83, 0
    v_mov_b32 v84, 0
    v_mov_b32 v85, 0
    v_mov_b32 v86, 0
    v_mov_b32 v87, 0
    v_mov_b32 v88, 0
    v_mov_b32 v89, 0
    v_mov_b32 v90, 0
    v_mov_b32 v91, 0
    v_mov_b32 v92, 0
    v_mov_b32 v93, 0
    v_mov_b32 v94, 0
    v_mov_b32 v95, 0
    v_mov_b32 v96, 0
    v_mov_b32 v97, 0
    v_mov_b32 v98, 0
    v_mov_b32 v99, 0
    v_mov_b32 v100, 0
    v_mov_b32 v101, 0
    v_mov_b32 v102, 0
    v_mov_b32 v103, 0
    v_mov_b32 v104, 0
    v_mov_b32 v105, 0
    v_mov_b32 v106, 0
    v_mov_b32 v107, 0
    v_mov_b32 v108, 0
    v_mov_b32 v109, 0
    v_mov_b32 v110, 0
    v_mov_b32 v111, 0
    v_mov_b32 v112, 0
    v_mov_b32 v113, 0
    v_mov_b32 v114, 0
    v_mov_b32 v115, 0
    v_mov_b32 v116, 0
    v_mov_b32 v117, 0
    v_mov_b32 v118, 0
    v_mov_b32 v119, 0
    v_mov_b32 v120, 0
    v_mov_b32 v121, 0
    v_mov_b32 v122, 0
    v_mov_b32 v123, 0
    v_mov_b32 v124, 0
    v_mov_b32 v125, 0
    v_mov_b32 v126, 0
    v_mov_b32 v127, 0
    s_mov_b32 s46, 0
    s_mov_b32 s48, 16
    s_mov_b32 s66, 0x2000000
    s_mov_b32 s67, 0x00020000
    s_cmp_eq_u32 s38, 1
    s_cbranch_scc1 p1_ktype
    s_cmp_eq_u32 s38, 2
    s_cbranch_scc1 p1_vtype
    s_cmp_eq_u32 s38, 3
    s_cbranch_scc1 p1_btype
    s_cmp_lg_u32 s39, 0
    s_cbranch_scc1 p1_nopf_1
    s_getpc_b64 s[72:73]
pc_2:
    s_add_u32 s72, s72, p1_loop_q-pc_2
    s_addc_u32 s73, s73, 0
    v_lshlrev_b32 v248, 3, v230
    v_min_u32 v248, p1_end_q-p1_loop_q-4, v248
    v_and_b32 v248, -4, v248
    v_add_co_u32 v248, vcc, s72, v248
    v_mov_b32 v249, s73
    v_addc_co_u32 v249, vcc, 0, v249, vcc
    global_load_dword v250, v[248:249], off
p1_nopf_1:
    s_mov_b32 s58, 0
    s_cmp_eq_u32 s38, 1
    s_cselect_b32 s58, 4194304, s58
    s_cmp_eq_u32 s38, 2
    s_cselect_b32 s58, 4196352, s58
    s_cmp_eq_u32 s38, 3
    s_cselect_b32 s58, 12582912, s58
    s_add_u32 s41, s38, 1
    s_and_b32 s41, s41, 2
    s_cmp_eq_u32 s41, 0
    s_mov_b32 s44, 262144
    s_cselect_b32 s59, 131072, s44
    s_mov_b32 s44, 4096
    s_cselect_b32 s60, 2048, s44
    s_mov_b32 s44, 1.0
    s_cselect_b32 s42, 0x3e8293ee, s44
    s_mov_b32 s43, s42
    s_lshl_b32 s41, s37, 2
    s_and_b32 s44, s39, 2
    s_add_u32 s41, s41, s44
    s_mul_i32 s41, s41, s59
    s_add_u32 s58, s58, s41
    s_lshl_b32 s41, s36, 3
    s_and_b32 s44, s39, 1
    s_lshl_b32 s44, s44, 2
    s_add_u32 s41, s41, s44
    s_mul_i32 s41, s41, s60
    s_add_u32 s58, s58, s41
    s_mov_b32 s48, 13
    s_barrier
    ds_read_b64_tr_b16 v[160:161], v226 offset:0
    ds_read_b64_tr_b16 v[162:163], v226 offset:1024
    ds_read_b128 v[128:131], v224 offset:0
    ds_read_b64_tr_b16 v[164:165], v227 offset:0
    ds_read_b64_tr_b16 v[166:167], v227 offset:1024
    ds_read_b128 v[132:135], v224 offset:2048
    ds_read_b64_tr_b16 v[168:169], v228 offset:0
    ds_read_b64_tr_b16 v[170:171], v228 offset:1024
    ds_read_b64_tr_b16 v[172:173], v229 offset:0
    ds_read_b64_tr_b16 v[174:175], v229 offset:1024
    ds_read_b128 v[136:139], v224 offset:4096
    ds_read_b128 v[140:143], v224 offset:6144
    ds_read_b128 v[144:147], v224 offset:8192
    ds_read_b128 v[148:151], v224 offset:10240
    ds_read_b128 v[152:155], v224 offset:12288
    ds_read_b128 v[156:159], v224 offset:14336
p1_loop_q:
    s_waitcnt lgkmcnt(0)
    v_mfma_f32_16x16x32_bf16 v[0:3], v[160:163], v[128:131], v[0:3]
    ds_read_b64_tr_b16 v[208:209], v226 offset:8192
    v_mfma_f32_16x16x32_bf16 v[8:11], v[164:167], v[128:131], v[8:11]
    ds_read_b64_tr_b16 v[210:211], v226 offset:9216
    v_mfma_f32_16x16x32_bf16 v[16:19], v[168:171], v[128:131], v[16:19]
    ds_read_b128 v[176:179], v225 offset:0
    v_mfma_f32_16x16x32_bf16 v[24:27], v[172:175], v[128:131], v[24:27]
    ds_read_b64_tr_b16 v[212:213], v227 offset:8192
    v_mfma_f32_16x16x32_bf16 v[4:7], v[160:163], v[132:135], v[4:7]
    ds_read_b64_tr_b16 v[214:215], v227 offset:9216
    v_mfma_f32_16x16x32_bf16 v[12:15], v[164:167], v[132:135], v[12:15]
    ds_read_b128 v[180:183], v225 offset:2048
    v_mfma_f32_16x16x32_bf16 v[20:23], v[168:171], v[132:135], v[20:23]
    ds_read_b64_tr_b16 v[216:217], v228 offset:8192
    v_mfma_f32_16x16x32_bf16 v[28:31], v[172:175], v[132:135], v[28:31]
    ds_read_b64_tr_b16 v[218:219], v228 offset:9216
    v_mfma_f32_16x16x32_bf16 v[32:35], v[160:163], v[136:139], v[32:35]
    ds_read_b64_tr_b16 v[220:221], v229 offset:8192
    v_mfma_f32_16x16x32_bf16 v[40:43], v[164:167], v[136:139], v[40:43]
    ds_read_b64_tr_b16 v[222:223], v229 offset:9216
    v_mfma_f32_16x16x32_bf16 v[48:51], v[168:171], v[136:139], v[48:51]
    ds_read_b128 v[184:187], v225 offset:4096
    v_mfma_f32_16x16x32_bf16 v[56:59], v[172:175], v[136:139], v[56:59]
    ds_read_b128 v[188:191], v225 offset:6144
    v_mfma_f32_16x16x32_bf16 v[36:39], v[160:163], v[140:143], v[36:39]
    ds_read_b128 v[192:195], v225 offset:8192
    v_mfma_f32_16x16x32_bf16 v[44:47], v[164:167], v[140:143], v[44:47]
    ds_read_b128 v[196:199], v225 offset:10240
    v_mfma_f32_16x16x32_bf16 v[52:55], v[168:171], v[140:143], v[52:55]
    ds_read_b128 v[200:203], v225 offset:12288
    v_mfma_f32_16x16x32_bf16 v[60:63], v[172:175], v[140:143], v[60:63]
    ds_read_b128 v[204:207], v225 offset:14336
    v_mfma_f32_16x16x32_bf16 v[64:67], v[160:163], v[144:147], v[64:67]
    v_mfma_f32_16x16x32_bf16 v[72:75], v[164:167], v[144:147], v[72:75]
    v_mfma_f32_16x16x32_bf16 v[80:83], v[168:171], v[144:147], v[80:83]
    v_mfma_f32_16x16x32_bf16 v[88:91], v[172:175], v[144:147], v[88:91]
    v_mfma_f32_16x16x32_bf16 v[68:71], v[160:163], v[148:151], v[68:71]
    v_mfma_f32_16x16x32_bf16 v[76:79], v[164:167], v[148:151], v[76:79]
    v_mfma_f32_16x16x32_bf16 v[84:87], v[168:171], v[148:151], v[84:87]
    v_mfma_f32_16x16x32_bf16 v[92:95], v[172:175], v[148:151], v[92:95]
    v_mfma_f32_16x16x32_bf16 v[96:99], v[160:163], v[152:155], v[96:99]
    v_mfma_f32_16x16x32_bf16 v[104:107], v[164:167], v[152:155], v[104:107]
    v_mfma_f32_16x16x32_bf16 v[112:115], v[168:171], v[152:155], v[112:115]
    v_mfma_f32_16x16x32_bf16 v[120:123], v[172:175], v[152:155], v[120:123]
    v_mfma_f32_16x16x32_bf16 v[100:103], v[160:163], v[156:159], v[100:103]
    v_mfma_f32_16x16x32_bf16 v[108:111], v[164:167], v[156:159], v[108:111]
    v_mfma_f32_16x16x32_bf16 v[116:119], v[168:171], v[156:159], v[116:119]
    v_mfma_f32_16x16x32_bf16 v[124:127], v[172:175], v[156:159], v[124:127]
    s_waitcnt lgkmcnt(0)
    v_mfma_f32_16x16x32_bf16 v[0:3], v[208:211], v[176:179], v[0:3]
    v_mfma_f32_16x16x32_bf16 v[8:11], v[212:215], v[176:179], v[8:11]
    v_mfma_f32_16x16x32_bf16 v[16:19], v[216:219], v[176:179], v[16:19]
    v_mfma_f32_16x16x32_bf16 v[24:27], v[220:223], v[176:179], v[24:27]
    v_mfma_f32_16x16x32_bf16 v[4:7], v[208:211], v[180:183], v[4:7]
    v_mfma_f32_16x16x32_bf16 v[12:15], v[212:215], v[180:183], v[12:15]
    v_mfma_f32_16x16x32_bf16 v[20:23], v[216:219], v[180:183], v[20:23]
    v_mfma_f32_16x16x32_bf16 v[28:31], v[220:223], v[180:183], v[28:31]
    s_add_u32 s46, s46, 53248
    s_mov_b32 s47, 53248
    s_cmp_eq_u32 s46, 159744
    s_cselect_b32 s47, 4294860800, s47
    s_cselect_b32 s46, 0, s46
    v_add_u32 v224, s47, v224
    v_add_u32 v225, s47, v225
    v_add_u32 v226, s47, v226
    v_add_u32 v227, s47, v227
    v_add_u32 v228, s47, v228
    v_add_u32 v229, s47, v229
    s_barrier
    v_mfma_f32_16x16x32_bf16 v[32:35], v[208:211], v[184:187], v[32:35]
    ds_read_b64_tr_b16 v[160:161], v226 offset:0
    v_mfma_f32_16x16x32_bf16 v[40:43], v[212:215], v[184:187], v[40:43]
    ds_read_b64_tr_b16 v[162:163], v226 offset:1024
    v_mfma_f32_16x16x32_bf16 v[48:51], v[216:219], v[184:187], v[48:51]
    ds_read_b128 v[128:131], v224 offset:0
    v_mfma_f32_16x16x32_bf16 v[56:59], v[220:223], v[184:187], v[56:59]
    ds_read_b64_tr_b16 v[164:165], v227 offset:0
    v_mfma_f32_16x16x32_bf16 v[36:39], v[208:211], v[188:191], v[36:39]
    ds_read_b64_tr_b16 v[166:167], v227 offset:1024
    v_mfma_f32_16x16x32_bf16 v[44:47], v[212:215], v[188:191], v[44:47]
    ds_read_b128 v[132:135], v224 offset:2048
    v_mfma_f32_16x16x32_bf16 v[52:55], v[216:219], v[188:191], v[52:55]
    ds_read_b64_tr_b16 v[168:169], v228 offset:0
    v_mfma_f32_16x16x32_bf16 v[60:63], v[220:223], v[188:191], v[60:63]
    ds_read_b64_tr_b16 v[170:171], v228 offset:1024
    v_mfma_f32_16x16x32_bf16 v[64:67], v[208:211], v[192:195], v[64:67]
    ds_read_b64_tr_b16 v[172:173], v229 offset:0
    v_mfma_f32_16x16x32_bf16 v[72:75], v[212:215], v[192:195], v[72:75]
    ds_read_b64_tr_b16 v[174:175], v229 offset:1024
    v_mfma_f32_16x16x32_bf16 v[80:83], v[216:219], v[192:195], v[80:83]
    ds_read_b128 v[136:139], v224 offset:4096
    v_mfma_f32_16x16x32_bf16 v[88:91], v[220:223], v[192:195], v[88:91]
    ds_read_b128 v[140:143], v224 offset:6144
    v_mfma_f32_16x16x32_bf16 v[68:71], v[208:211], v[196:199], v[68:71]
    ds_read_b128 v[144:147], v224 offset:8192
    v_mfma_f32_16x16x32_bf16 v[76:79], v[212:215], v[196:199], v[76:79]
    ds_read_b128 v[148:151], v224 offset:10240
    v_mfma_f32_16x16x32_bf16 v[84:87], v[216:219], v[196:199], v[84:87]
    ds_read_b128 v[152:155], v224 offset:12288
    v_mfma_f32_16x16x32_bf16 v[92:95], v[220:223], v[196:199], v[92:95]
    ds_read_b128 v[156:159], v224 offset:14336
    v_mfma_f32_16x16x32_bf16 v[96:99], v[208:211], v[200:203], v[96:99]
    v_mfma_f32_16x16x32_bf16 v[104:107], v[212:215], v[200:203], v[104:107]
    v_mfma_f32_16x16x32_bf16 v[112:115], v[216:219], v[200:203], v[112:115]
    v_mfma_f32_16x16x32_bf16 v[120:123], v[220:223], v[200:203], v[120:123]
    v_mfma_f32_16x16x32_bf16 v[100:103], v[208:211], v[204:207], v[100:103]
    v_mfma_f32_16x16x32_bf16 v[108:111], v[212:215], v[204:207], v[108:111]
    v_mfma_f32_16x16x32_bf16 v[116:119], v[216:219], v[204:207], v[116:119]
    v_mfma_f32_16x16x32_bf16 v[124:127], v[220:223], v[204:207], v[124:127]
    s_sub_u32 s48, s48, 1
    s_cmp_lg_u32 s48, 0
    s_cbranch_scc1 p1_loop_q
    s_waitcnt lgkmcnt(0) vmcnt(0)
    v_mfma_f32_16x16x32_bf16 v[0:3], v[160:163], v[128:131], v[0:3]
    ds_read_b64_tr_b16 v[208:209], v226 offset:8192
    v_mfma_f32_16x16x32_bf16 v[8:11], v[164:167], v[128:131], v[8:11]
    ds_read_b64_tr_b16 v[210:211], v226 offset:9216
    v_mfma_f32_16x16x32_bf16 v[16:19], v[168:171], v[128:131], v[16:19]
    ds_read_b128 v[176:179], v225 offset:0
    v_mfma_f32_16x16x32_bf16 v[24:27], v[172:175], v[128:131], v[24:27]
    ds_read_b64_tr_b16 v[212:213], v227 offset:8192
    v_mfma_f32_16x16x32_bf16 v[4:7], v[160:163], v[132:135], v[4:7]
    ds_read_b64_tr_b16 v[214:215], v227 offset:9216
    v_mfma_f32_16x16x32_bf16 v[12:15], v[164:167], v[132:135], v[12:15]
    ds_read_b128 v[180:183], v225 offset:2048
    v_mfma_f32_16x16x32_bf16 v[20:23], v[168:171], v[132:135], v[20:23]
    ds_read_b64_tr_b16 v[216:217], v228 offset:8192
    v_mfma_f32_16x16x32_bf16 v[28:31], v[172:175], v[132:135], v[28:31]
    ds_read_b64_tr_b16 v[218:219], v228 offset:9216
    v_mfma_f32_16x16x32_bf16 v[32:35], v[160:163], v[136:139], v[32:35]
    ds_read_b64_tr_b16 v[220:221], v229 offset:8192
    v_mfma_f32_16x16x32_bf16 v[40:43], v[164:167], v[136:139], v[40:43]
    ds_read_b64_tr_b16 v[222:223], v229 offset:9216
    v_mfma_f32_16x16x32_bf16 v[48:51], v[168:171], v[136:139], v[48:51]
    ds_read_b128 v[184:187], v225 offset:4096
    v_mfma_f32_16x16x32_bf16 v[56:59], v[172:175], v[136:139], v[56:59]
    ds_read_b128 v[188:191], v225 offset:6144
    v_mfma_f32_16x16x32_bf16 v[36:39], v[160:163], v[140:143], v[36:39]
    ds_read_b128 v[192:195], v225 offset:8192
    v_mfma_f32_16x16x32_bf16 v[44:47], v[164:167], v[140:143], v[44:47]
    ds_read_b128 v[196:199], v225 offset:10240
    v_mfma_f32_16x16x32_bf16 v[52:55], v[168:171], v[140:143], v[52:55]
    ds_read_b128 v[200:203], v225 offset:12288
    v_mfma_f32_16x16x32_bf16 v[60:63], v[172:175], v[140:143], v[60:63]
    ds_read_b128 v[204:207], v225 offset:14336
    v_mfma_f32_16x16x32_bf16 v[64:67], v[160:163], v[144:147], v[64:67]
    v_mfma_f32_16x16x32_bf16 v[72:75], v[164:167], v[144:147], v[72:75]
    v_mfma_f32_16x16x32_bf16 v[80:83], v[168:171], v[144:147], v[80:83]
    v_mfma_f32_16x16x32_bf16 v[88:91], v[172:175], v[144:147], v[88:91]
    v_mfma_f32_16x16x32_bf16 v[68:71], v[160:163], v[148:151], v[68:71]
    v_mfma_f32_16x16x32_bf16 v[76:79], v[164:167], v[148:151], v[76:79]
    v_mfma_f32_16x16x32_bf16 v[84:87], v[168:171], v[148:151], v[84:87]
    v_mfma_f32_16x16x32_bf16 v[92:95], v[172:175], v[148:151], v[92:95]
    v_mfma_f32_16x16x32_bf16 v[96:99], v[160:163], v[152:155], v[96:99]
    v_mfma_f32_16x16x32_bf16 v[104:107], v[164:167], v[152:155], v[104:107]
    v_mfma_f32_16x16x32_bf16 v[112:115], v[168:171], v[152:155], v[112:115]
    v_mfma_f32_16x16x32_bf16 v[120:123], v[172:175], v[152:155], v[120:123]
    v_mfma_f32_16x16x32_bf16 v[100:103], v[160:163], v[156:159], v[100:103]
    v_mfma_f32_16x16x32_bf16 v[108:111], v[164:167], v[156:159], v[108:111]
    v_mfma_f32_16x16x32_bf16 v[116:119], v[168:171], v[156:159], v[116:119]
    v_mfma_f32_16x16x32_bf16 v[124:127], v[172:175], v[156:159], v[124:127]
    s_waitcnt lgkmcnt(0)
    v_mfma_f32_16x16x32_bf16 v[0:3], v[208:211], v[176:179], v[0:3]
    v_add_u32 v248, 4294914048, v224
    v_add_u32 v224, 53248, v224
    v_mfma_f32_16x16x32_bf16 v[8:11], v[212:215], v[176:179], v[8:11]
    v_add_u32 v249, 4294914048, v225
    v_add_u32 v225, 53248, v225
    v_mfma_f32_16x16x32_bf16 v[16:19], v[216:219], v[176:179], v[16:19]
    v_add_u32 v250, 4294914048, v226
    v_add_u32 v226, 53248, v226
    v_mfma_f32_16x16x32_bf16 v[24:27], v[220:223], v[176:179], v[24:27]
    v_add_u32 v251, 4294914048, v227
    v_add_u32 v227, 53248, v227
    v_mfma_f32_16x16x32_bf16 v[4:7], v[208:211], v[180:183], v[4:7]
    v_add_u32 v252, 4294914048, v228
    v_add_u32 v228, 53248, v228
    v_mfma_f32_16x16x32_bf16 v[12:15], v[212:215], v[180:183], v[12:15]
    v_add_u32 v253, 4294914048, v229
    v_add_u32 v229, 53248, v229
    v_mfma_f32_16x16x32_bf16 v[20:23], v[216:219], v[180:183], v[20:23]
    v_mfma_f32_16x16x32_bf16 v[28:31], v[220:223], v[180:183], v[28:31]
    s_barrier
    v_mfma_f32_16x16x32_bf16 v[32:35], v[208:211], v[184:187], v[32:35]
    ds_read_b64_tr_b16 v[160:161], v226 offset:0
    v_mfma_f32_16x16x32_bf16 v[40:43], v[212:215], v[184:187], v[40:43]
    ds_read_b64_tr_b16 v[162:163], v226 offset:1024
    v_mfma_f32_16x16x32_bf16 v[48:51], v[216:219], v[184:187], v[48:51]
    ds_read_b128 v[144:147], v224 offset:0
    v_mfma_f32_16x16x32_bf16 v[56:59], v[220:223], v[184:187], v[56:59]
    ds_read_b64_tr_b16 v[164:165], v227 offset:0
    v_mfma_f32_16x16x32_bf16 v[36:39], v[208:211], v[188:191], v[36:39]
    ds_read_b64_tr_b16 v[166:167], v227 offset:1024
    v_mfma_f32_16x16x32_bf16 v[44:47], v[212:215], v[188:191], v[44:47]
    ds_read_b128 v[148:151], v224 offset:2048
    v_mfma_f32_16x16x32_bf16 v[52:55], v[216:219], v[188:191], v[52:55]
    ds_read_b64_tr_b16 v[168:169], v228 offset:0
    v_mfma_f32_16x16x32_bf16 v[60:63], v[220:223], v[188:191], v[60:63]
    ds_read_b64_tr_b16 v[170:171], v228 offset:1024
    v_mfma_f32_16x16x32_bf16 v[64:67], v[208:211], v[192:195], v[64:67]
    ds_read_b64_tr_b16 v[172:173], v229 offset:0
    v_mfma_f32_16x16x32_bf16 v[72:75], v[212:215], v[192:195], v[72:75]
    ds_read_b64_tr_b16 v[174:175], v229 offset:1024
    v_mfma_f32_16x16x32_bf16 v[80:83], v[216:219], v[192:195], v[80:83]
    ds_read_b64_tr_b16 v[128:129], v226 offset:8192
    v_mfma_f32_16x16x32_bf16 v[88:91], v[220:223], v[192:195], v[88:91]
    ds_read_b64_tr_b16 v[130:131], v226 offset:9216
    v_mfma_f32_16x16x32_bf16 v[68:71], v[208:211], v[196:199], v[68:71]
    ds_read_b128 v[152:155], v225 offset:0
    v_mfma_f32_16x16x32_bf16 v[76:79], v[212:215], v[196:199], v[76:79]
    ds_read_b64_tr_b16 v[132:133], v227 offset:8192
    v_mfma_f32_16x16x32_bf16 v[84:87], v[216:219], v[196:199], v[84:87]
    ds_read_b64_tr_b16 v[134:135], v227 offset:9216
    v_mfma_f32_16x16x32_bf16 v[92:95], v[220:223], v[196:199], v[92:95]
    ds_read_b128 v[156:159], v225 offset:2048
    v_mfma_f32_16x16x32_bf16 v[96:99], v[208:211], v[200:203], v[96:99]
    ds_read_b64_tr_b16 v[136:137], v228 offset:8192
    v_mfma_f32_16x16x32_bf16 v[104:107], v[212:215], v[200:203], v[104:107]
    ds_read_b64_tr_b16 v[138:139], v228 offset:9216
    s_barrier
    v_mfma_f32_16x16x32_bf16 v[112:115], v[216:219], v[200:203], v[112:115]
    ds_read_b64_tr_b16 v[140:141], v229 offset:8192
    v_mfma_f32_16x16x32_bf16 v[120:123], v[220:223], v[200:203], v[120:123]
    ds_read_b64_tr_b16 v[142:143], v229 offset:9216
    v_mfma_f32_16x16x32_bf16 v[100:103], v[208:211], v[204:207], v[100:103]
    ds_read_b64_tr_b16 v[176:177], v250 offset:0
    v_mfma_f32_16x16x32_bf16 v[108:111], v[212:215], v[204:207], v[108:111]
    ds_read_b64_tr_b16 v[178:179], v250 offset:1024
    v_mfma_f32_16x16x32_bf16 v[116:119], v[216:219], v[204:207], v[116:119]
    ds_read_b64_tr_b16 v[180:181], v251 offset:0
    v_mfma_f32_16x16x32_bf16 v[124:127], v[220:223], v[204:207], v[124:127]
    ds_read_b64_tr_b16 v[182:183], v251 offset:1024
    s_waitcnt lgkmcnt(14)
    v_mfma_f32_16x16x32_bf16 v[0:3], v[160:163], v[144:147], v[0:3]
    ds_read_b64_tr_b16 v[184:185], v252 offset:0
    ds_read_b64_tr_b16 v[186:187], v252 offset:1024
    v_mfma_f32_16x16x32_bf16 v[8:11], v[164:167], v[144:147], v[8:11]
    ds_read_b64_tr_b16 v[188:189], v253 offset:0
    ds_read_b64_tr_b16 v[190:191], v253 offset:1024
    v_mfma_f32_16x16x32_bf16 v[16:19], v[168:171], v[144:147], v[16:19]
    ds_read_b128 v[192:195], v248 offset:0
    ds_read_b128 v[196:199], v248 offset:2048
    v_mfma_f32_16x16x32_bf16 v[24:27], v[172:175], v[144:147], v[24:27]
    ds_read_b64_tr_b16 v[208:209], v250 offset:8192
    ds_read_b64_tr_b16 v[210:211], v250 offset:9216
    v_mfma_f32_16x16x32_bf16 v[4:7], v[160:163], v[148:151], v[4:7]
    ds_read_b64_tr_b16 v[212:213], v251 offset:8192
    ds_read_b64_tr_b16 v[214:215], v251 offset:9216
    v_mfma_f32_16x16x32_bf16 v[12:15], v[164:167], v[148:151], v[12:15]
    ds_read_b64_tr_b16 v[216:217], v252 offset:8192
    ds_read_b64_tr_b16 v[218:219], v252 offset:9216
    v_mfma_f32_16x16x32_bf16 v[20:23], v[168:171], v[148:151], v[20:23]
    ds_read_b64_tr_b16 v[220:221], v253 offset:8192
    ds_read_b64_tr_b16 v[222:223], v253 offset:9216
    v_mfma_f32_16x16x32_bf16 v[28:31], v[172:175], v[148:151], v[28:31]
    ds_read_b128 v[200:203], v249 offset:0
    ds_read_b128 v[204:207], v249 offset:2048
    s_waitcnt lgkmcnt(15)
    v_mfma_f32_16x16x32_bf16 v[0:3], v[128:131], v[152:155], v[0:3]
    v_mfma_f32_16x16x32_bf16 v[8:11], v[132:135], v[152:155], v[8:11]
    v_mfma_f32_16x16x32_bf16 v[16:19], v[136:139], v[152:155], v[16:19]
    v_mfma_f32_16x16x32_bf16 v[24:27], v[140:143], v[152:155], v[24:27]
    v_mfma_f32_16x16x32_bf16 v[4:7], v[128:131], v[156:159], v[4:7]
    v_mfma_f32_16x16x32_bf16 v[12:15], v[132:135], v[156:159], v[12:15]
    v_mfma_f32_16x16x32_bf16 v[20:23], v[136:139], v[156:159], v[20:23]
    v_mfma_f32_16x16x32_bf16 v[28:31], v[140:143], v[156:159], v[28:31]
    s_waitcnt lgkmcnt(11)
    v_mfma_f32_16x16x32_bf16 v[0:3], v[176:179], v[192:195], v[0:3]
    ds_read_b128 v[144:147], v224 offset:8192
    ds_read_b128 v[148:151], v224 offset:10240
    v_mfma_f32_16x16x32_bf16 v[8:11], v[180:183], v[192:195], v[8:11]
    ds_read_b128 v[152:155], v225 offset:8192
    ds_read_b128 v[156:159], v225 offset:10240
    v_mfma_f32_16x16x32_bf16 v[16:19], v[184:187], v[192:195], v[16:19]
    v_mfma_f32_16x16x32_bf16 v[24:27], v[188:191], v[192:195], v[24:27]
    s_waitcnt lgkmcnt(14)
    v_mfma_f32_16x16x32_bf16 v[4:7], v[176:179], v[196:199], v[4:7]
    v_mfma_f32_16x16x32_bf16 v[12:15], v[180:183], v[196:199], v[12:15]
    v_mfma_f32_16x16x32_bf16 v[20:23], v[184:187], v[196:199], v[20:23]
    v_mfma_f32_16x16x32_bf16 v[28:31], v[188:191], v[196:199], v[28:31]
    s_waitcnt lgkmcnt(5)
    v_mfma_f32_16x16x32_bf16 v[0:3], v[208:211], v[200:203], v[0:3]
    v_mfma_f32_16x16x32_bf16 v[8:11], v[212:215], v[200:203], v[8:11]
    v_mfma_f32_16x16x32_bf16 v[16:19], v[216:219], v[200:203], v[16:19]
    v_mfma_f32_16x16x32_bf16 v[24:27], v[220:223], v[200:203], v[24:27]
    s_waitcnt lgkmcnt(4)
    v_mfma_f32_16x16x32_bf16 v[4:7], v[208:211], v[204:207], v[4:7]
    v_mfma_f32_16x16x32_bf16 v[12:15], v[212:215], v[204:207], v[12:15]
    v_mfma_f32_16x16x32_bf16 v[20:23], v[216:219], v[204:207], v[20:23]
    v_mfma_f32_16x16x32_bf16 v[28:31], v[220:223], v[204:207], v[28:31]
    s_waitcnt lgkmcnt(3)
    v_mfma_f32_16x16x32_bf16 v[64:67], v[160:163], v[144:147], v[64:67]
    ds_read_b128 v[192:195], v248 offset:8192
    v_mfma_f32_16x16x32_bf16 v[72:75], v[164:167], v[144:147], v[72:75]
    ds_read_b128 v[196:199], v248 offset:10240
    v_pk_mul_f32 v[0:1], v[0:1], s[42:43]
    v_mfma_f32_16x16x32_bf16 v[80:83], v[168:171], v[144:147], v[80:83]
    ds_read_b128 v[200:203], v249 offset:8192
    v_pk_mul_f32 v[2:3], v[2:3], s[42:43]
    v_mfma_f32_16x16x32_bf16 v[88:91], v[172:175], v[144:147], v[88:91]
    ds_read_b128 v[204:207], v249 offset:10240
    v_pk_mul_f32 v[4:5], v[4:5], s[42:43]
    s_waitcnt lgkmcnt(6)
    v_mfma_f32_16x16x32_bf16 v[68:71], v[160:163], v[148:151], v[68:71]
    v_pk_mul_f32 v[6:7], v[6:7], s[42:43]
    v_cvt_pk_bf16_f32 v0, v0, v1
    v_mfma_f32_16x16x32_bf16 v[76:79], v[164:167], v[148:151], v[76:79]
    v_cvt_pk_bf16_f32 v1, v2, v3
    v_cvt_pk_bf16_f32 v2, v4, v5
    v_mfma_f32_16x16x32_bf16 v[84:87], v[168:171], v[148:151], v[84:87]
    v_cvt_pk_bf16_f32 v3, v6, v7
    v_pk_mul_f32 v[8:9], v[8:9], s[42:43]
    v_mfma_f32_16x16x32_bf16 v[92:95], v[172:175], v[148:151], v[92:95]
    v_pk_mul_f32 v[10:11], v[10:11], s[42:43]
    v_pk_mul_f32 v[12:13], v[12:13], s[42:43]
    s_waitcnt lgkmcnt(5)
    v_mfma_f32_16x16x32_bf16 v[64:67], v[128:131], v[152:155], v[64:67]
    v_pk_mul_f32 v[14:15], v[14:15], s[42:43]
    v_cvt_pk_bf16_f32 v8, v8, v9
    v_mfma_f32_16x16x32_bf16 v[72:75], v[132:135], v[152:155], v[72:75]
    v_cvt_pk_bf16_f32 v9, v10, v11
    v_cvt_pk_bf16_f32 v10, v12, v13
    v_mfma_f32_16x16x32_bf16 v[80:83], v[136:139], v[152:155], v[80:83]
    v_cvt_pk_bf16_f32 v11, v14, v15
    s_mov_b32 s41, s58
    v_mfma_f32_16x16x32_bf16 v[88:91], v[140:143], v[152:155], v[88:91]
    v_permlane16_swap_b32 v0, v2
    v_permlane16_swap_b32 v1, v3
    s_waitcnt lgkmcnt(4)
    v_mfma_f32_16x16x32_bf16 v[68:71], v[128:131], v[156:159], v[68:71]
    v_permlane16_swap_b32 v8, v10
    v_permlane16_swap_b32 v9, v11
    v_mfma_f32_16x16x32_bf16 v[76:79], v[132:135], v[156:159], v[76:79]
    buffer_store_dwordx4 v[0:3], v230, s[64:67], s41 offen offset:0 sc1
    buffer_store_dwordx4 v[8:11], v230, s[64:67], s41 offen offset:1024 sc1
    v_mfma_f32_16x16x32_bf16 v[84:87], v[136:139], v[156:159], v[84:87]
    v_pk_mul_f32 v[16:17], v[16:17], s[42:43]
    v_pk_mul_f32 v[18:19], v[18:19], s[42:43]
    v_mfma_f32_16x16x32_bf16 v[92:95], v[140:143], v[156:159], v[92:95]
    v_pk_mul_f32 v[20:21], v[20:21], s[42:43]
    v_pk_mul_f32 v[22:23], v[22:23], s[42:43]
    s_waitcnt lgkmcnt(3)
    v_mfma_f32_16x16x32_bf16 v[64:67], v[176:179], v[192:195], v[64:67]
    ds_read_b128 v[144:147], v224 offset:4096
    v_cvt_pk_bf16_f32 v16, v16, v17
    v_mfma_f32_16x16x32_bf16 v[72:75], v[180:183], v[192:195], v[72:75]
    ds_read_b128 v[148:151], v224 offset:6144
    v_cvt_pk_bf16_f32 v17, v18, v19
    v_mfma_f32_16x16x32_bf16 v[80:83], v[184:187], v[192:195], v[80:83]
    ds_read_b128 v[152:155], v225 offset:4096
    v_cvt_pk_bf16_f32 v18, v20, v21
    v_mfma_f32_16x16x32_bf16 v[88:91], v[188:191], v[192:195], v[88:91]
    ds_read_b128 v[156:159], v225 offset:6144
    v_cvt_pk_bf16_f32 v19, v22, v23
    s_waitcnt lgkmcnt(6)
    v_mfma_f32_16x16x32_bf16 v[68:71], v[176:179], v[196:199], v[68:71]
    v_pk_mul_f32 v[24:25], v[24:25], s[42:43]
    v_pk_mul_f32 v[26:27], v[26:27], s[42:43]
    v_mfma_f32_16x16x32_bf16 v[76:79], v[180:183], v[196:199], v[76:79]
    v_pk_mul_f32 v[28:29], v[28:29], s[42:43]
    v_pk_mul_f32 v[30:31], v[30:31], s[42:43]
    v_mfma_f32_16x16x32_bf16 v[84:87], v[184:187], v[196:199], v[84:87]
    v_cvt_pk_bf16_f32 v24, v24, v25
    v_cvt_pk_bf16_f32 v25, v26, v27
    v_mfma_f32_16x16x32_bf16 v[92:95], v[188:191], v[196:199], v[92:95]
    v_cvt_pk_bf16_f32 v26, v28, v29
    v_cvt_pk_bf16_f32 v27, v30, v31
    s_waitcnt lgkmcnt(5)
    v_mfma_f32_16x16x32_bf16 v[64:67], v[208:211], v[200:203], v[64:67]
    s_add_u32 s41, s41, s59
    v_permlane16_swap_b32 v16, v18
    v_mfma_f32_16x16x32_bf16 v[72:75], v[212:215], v[200:203], v[72:75]
    v_permlane16_swap_b32 v17, v19
    v_permlane16_swap_b32 v24, v26
    v_mfma_f32_16x16x32_bf16 v[80:83], v[216:219], v[200:203], v[80:83]
    v_permlane16_swap_b32 v25, v27
    buffer_store_dwordx4 v[16:19], v230, s[64:67], s41 offen offset:0 sc1
    v_mfma_f32_16x16x32_bf16 v[88:91], v[220:223], v[200:203], v[88:91]
    buffer_store_dwordx4 v[24:27], v230, s[64:67], s41 offen offset:1024 sc1
    s_waitcnt lgkmcnt(4)
    v_mfma_f32_16x16x32_bf16 v[68:71], v[208:211], v[204:207], v[68:71]
    v_mfma_f32_16x16x32_bf16 v[76:79], v[212:215], v[204:207], v[76:79]
    v_mfma_f32_16x16x32_bf16 v[84:87], v[216:219], v[204:207], v[84:87]
    v_mfma_f32_16x16x32_bf16 v[92:95], v[220:223], v[204:207], v[92:95]
    s_barrier
    s_waitcnt lgkmcnt(3)
    v_mfma_f32_16x16x32_bf16 v[32:35], v[160:163], v[144:147], v[32:35]
    ds_read_b128 v[192:195], v248 offset:4096
    v_mfma_f32_16x16x32_bf16 v[40:43], v[164:167], v[144:147], v[40:43]
    ds_read_b128 v[196:199], v248 offset:6144
    v_pk_mul_f32 v[64:65], v[64:65], s[42:43]
    v_mfma_f32_16x16x32_bf16 v[48:51], v[168:171], v[144:147], v[48:51]
    ds_read_b128 v[200:203], v249 offset:4096
    v_pk_mul_f32 v[66:67], v[66:67], s[42:43]
    v_mfma_f32_16x16x32_bf16 v[56:59], v[172:175], v[144:147], v[56:59]
    ds_read_b128 v[204:207], v249 offset:6144
    v_pk_mul_f32 v[68:69], v[68:69], s[42:43]
    s_waitcnt lgkmcnt(6)
    v_mfma_f32_16x16x32_bf16 v[36:39], v[160:163], v[148:151], v[36:39]
    v_pk_mul_f32 v[70:71], v[70:71], s[42:43]
    v_cvt_pk_bf16_f32 v64, v64, v65
    v_mfma_f32_16x16x32_bf16 v[44:47], v[164:167], v[148:151], v[44:47]
    v_cvt_pk_bf16_f32 v65, v66, v67
    v_cvt_pk_bf16_f32 v66, v68, v69
    v_mfma_f32_16x16x32_bf16 v[52:55], v[168:171], v[148:151], v[52:55]
    v_cvt_pk_bf16_f32 v67, v70, v71
    v_pk_mul_f32 v[72:73], v[72:73], s[42:43]
    v_mfma_f32_16x16x32_bf16 v[60:63], v[172:175], v[148:151], v[60:63]
    v_pk_mul_f32 v[74:75], v[74:75], s[42:43]
    v_pk_mul_f32 v[76:77], v[76:77], s[42:43]
    s_waitcnt lgkmcnt(5)
    v_mfma_f32_16x16x32_bf16 v[32:35], v[128:131], v[152:155], v[32:35]
    v_pk_mul_f32 v[78:79], v[78:79], s[42:43]
    v_cvt_pk_bf16_f32 v72, v72, v73
    v_mfma_f32_16x16x32_bf16 v[40:43], v[132:135], v[152:155], v[40:43]
    v_cvt_pk_bf16_f32 v73, v74, v75
    v_cvt_pk_bf16_f32 v74, v76, v77
    v_mfma_f32_16x16x32_bf16 v[48:51], v[136:139], v[152:155], v[48:51]
    v_cvt_pk_bf16_f32 v75, v78, v79
    s_mul_i32 s41, s60, 2
    v_mfma_f32_16x16x32_bf16 v[56:59], v[140:143], v[152:155], v[56:59]
    s_add_u32 s41, s41, s58
    v_permlane16_swap_b32 v64, v66
    s_waitcnt lgkmcnt(4)
    v_mfma_f32_16x16x32_bf16 v[36:39], v[128:131], v[156:159], v[36:39]
    v_permlane16_swap_b32 v65, v67
    v_permlane16_swap_b32 v72, v74
    v_mfma_f32_16x16x32_bf16 v[44:47], v[132:135], v[156:159], v[44:47]
    v_permlane16_swap_b32 v73, v75
    buffer_store_dwordx4 v[64:67], v230, s[64:67], s41 offen offset:0 sc1
    v_mfma_f32_16x16x32_bf16 v[52:55], v[136:139], v[156:159], v[52:55]
    buffer_store_dwordx4 v[72:75], v230, s[64:67], s41 offen offset:1024 sc1
    v_pk_mul_f32 v[80:81], v[80:81], s[42:43]
    v_mfma_f32_16x16x32_bf16 v[60:63], v[140:143], v[156:159], v[60:63]
    v_pk_mul_f32 v[82:83], v[82:83], s[42:43]
    v_pk_mul_f32 v[84:85], v[84:85], s[42:43]
    s_waitcnt lgkmcnt(3)
    v_mfma_f32_16x16x32_bf16 v[32:35], v[176:179], v[192:195], v[32:35]
    ds_read_b128 v[144:147], v224 offset:12288
    v_pk_mul_f32 v[86:87], v[86:87], s[42:43]
    v_mfma_f32_16x16x32_bf16 v[40:43], v[180:183], v[192:195], v[40:43]
    ds_read_b128 v[148:151], v224 offset:14336
    v_cvt_pk_bf16_f32 v80, v80, v81
    v_mfma_f32_16x16x32_bf16 v[48:51], v[184:187], v[192:195], v[48:51]
    ds_read_b128 v[152:155], v225 offset:12288
    v_cvt_pk_bf16_f32 v81, v82, v83
    v_mfma_f32_16x16x32_bf16 v[56:59], v[188:191], v[192:195], v[56:59]
    ds_read_b128 v[156:159], v225 offset:14336
    v_cvt_pk_bf16_f32 v82, v84, v85
    s_waitcnt lgkmcnt(6)
    v_mfma_f32_16x16x32_bf16 v[36:39], v[176:179], v[196:199], v[36:39]
    v_cvt_pk_bf16_f32 v83, v86, v87
    v_pk_mul_f32 v[88:89], v[88:89], s[42:43]
    v_mfma_f32_16x16x32_bf16 v[44:47], v[180:183], v[196:199], v[44:47]
    v_pk_mul_f32 v[90:91], v[90:91], s[42:43]
    v_pk_mul_f32 v[92:93], v[92:93], s[42:43]
    v_mfma_f32_16x16x32_bf16 v[52:55], v[184:187], v[196:199], v[52:55]
    v_pk_mul_f32 v[94:95], v[94:95], s[42:43]
    v_cvt_pk_bf16_f32 v88, v88, v89
    v_mfma_f32_16x16x32_bf16 v[60:63], v[188:191], v[196:199], v[60:63]
    v_cvt_pk_bf16_f32 v89, v90, v91
    v_cvt_pk_bf16_f32 v90, v92, v93
    s_waitcnt lgkmcnt(5)
    v_mfma_f32_16x16x32_bf16 v[32:35], v[208:211], v[200:203], v[32:35]
    v_cvt_pk_bf16_f32 v91, v94, v95
    s_add_u32 s41, s41, s59
    v_mfma_f32_16x16x32_bf16 v[40:43], v[212:215], v[200:203], v[40:43]
    v_permlane16_swap_b32 v80, v82
    v_permlane16_swap_b32 v81, v83
    v_mfma_f32_16x16x32_bf16 v[48:51], v[216:219], v[200:203], v[48:51]
    v_permlane16_swap_b32 v88, v90
    v_permlane16_swap_b32 v89, v91
    v_mfma_f32_16x16x32_bf16 v[56:59], v[220:223], v[200:203], v[56:59]
    buffer_store_dwordx4 v[80:83], v230, s[64:67], s41 offen offset:0 sc1
    buffer_store_dwordx4 v[88:91], v230, s[64:67], s41 offen offset:1024 sc1
    s_waitcnt lgkmcnt(4)
    v_mfma_f32_16x16x32_bf16 v[36:39], v[208:211], v[204:207], v[36:39]
    v_mfma_f32_16x16x32_bf16 v[44:47], v[212:215], v[204:207], v[44:47]
    v_mfma_f32_16x16x32_bf16 v[52:55], v[216:219], v[204:207], v[52:55]
    v_mfma_f32_16x16x32_bf16 v[60:63], v[220:223], v[204:207], v[60:63]
    s_waitcnt lgkmcnt(3)
    v_mfma_f32_16x16x32_bf16 v[96:99], v[160:163], v[144:147], v[96:99]
    ds_read_b128 v[192:195], v248 offset:12288
    v_mfma_f32_16x16x32_bf16 v[104:107], v[164:167], v[144:147], v[104:107]
    ds_read_b128 v[196:199], v248 offset:14336
    v_pk_mul_f32 v[32:33], v[32:33], s[42:43]
    v_mfma_f32_16x16x32_bf16 v[112:115], v[168:171], v[144:147], v[112:115]
    ds_read_b128 v[200:203], v249 offset:12288
    v_pk_mul_f32 v[34:35], v[34:35], s[42:43]
    v_mfma_f32_16x16x32_bf16 v[120:123], v[172:175], v[144:147], v[120:123]
    ds_read_b128 v[204:207], v249 offset:14336
    v_pk_mul_f32 v[36:37], v[36:37], s[42:43]
    s_waitcnt lgkmcnt(6)
    v_mfma_f32_16x16x32_bf16 v[100:103], v[160:163], v[148:151], v[100:103]
    v_pk_mul_f32 v[38:39], v[38:39], s[42:43]
    v_cvt_pk_bf16_f32 v32, v32, v33
    v_mfma_f32_16x16x32_bf16 v[108:111], v[164:167], v[148:151], v[108:111]
    v_cvt_pk_bf16_f32 v33, v34, v35
    v_cvt_pk_bf16_f32 v34, v36, v37
    v_mfma_f32_16x16x32_bf16 v[116:119], v[168:171], v[148:151], v[116:119]
    v_cvt_pk_bf16_f32 v35, v38, v39
    v_pk_mul_f32 v[40:41], v[40:41], s[42:43]
    v_mfma_f32_16x16x32_bf16 v[124:127], v[172:175], v[148:151], v[124:127]
    v_pk_mul_f32 v[42:43], v[42:43], s[42:43]
    v_pk_mul_f32 v[44:45], v[44:45], s[42:43]
    s_waitcnt lgkmcnt(5)
    v_mfma_f32_16x16x32_bf16 v[96:99], v[128:131], v[152:155], v[96:99]
    v_pk_mul_f32 v[46:47], v[46:47], s[42:43]
    v_cvt_pk_bf16_f32 v40, v40, v41
    v_mfma_f32_16x16x32_bf16 v[104:107], v[132:135], v[152:155], v[104:107]
    v_cvt_pk_bf16_f32 v41, v42, v43
    v_cvt_pk_bf16_f32 v42, v44, v45
    v_mfma_f32_16x16x32_bf16 v[112:115], v[136:139], v[152:155], v[112:115]
    v_cvt_pk_bf16_f32 v43, v46, v47
    s_mul_i32 s41, s60, 1
    v_mfma_f32_16x16x32_bf16 v[120:123], v[140:143], v[152:155], v[120:123]
    s_add_u32 s41, s41, s58
    v_permlane16_swap_b32 v32, v34
    s_waitcnt lgkmcnt(4)
    v_mfma_f32_16x16x32_bf16 v[100:103], v[128:131], v[156:159], v[100:103]
    v_permlane16_swap_b32 v33, v35
    v_permlane16_swap_b32 v40, v42
    v_mfma_f32_16x16x32_bf16 v[108:111], v[132:135], v[156:159], v[108:111]
    v_permlane16_swap_b32 v41, v43
    buffer_store_dwordx4 v[32:35], v230, s[64:67], s41 offen offset:0 sc1
    v_mfma_f32_16x16x32_bf16 v[116:119], v[136:139], v[156:159], v[116:119]
    buffer_store_dwordx4 v[40:43], v230, s[64:67], s41 offen offset:1024 sc1
    v_pk_mul_f32 v[48:49], v[48:49], s[42:43]
    v_mfma_f32_16x16x32_bf16 v[124:127], v[140:143], v[156:159], v[124:127]
    v_pk_mul_f32 v[50:51], v[50:51], s[42:43]
    v_pk_mul_f32 v[52:53], v[52:53], s[42:43]
    s_waitcnt lgkmcnt(3)
    v_mfma_f32_16x16x32_bf16 v[96:99], v[176:179], v[192:195], v[96:99]
    v_pk_mul_f32 v[54:55], v[54:55], s[42:43]
    v_cvt_pk_bf16_f32 v48, v48, v49
    v_mfma_f32_16x16x32_bf16 v[104:107], v[180:183], v[192:195], v[104:107]
    v_cvt_pk_bf16_f32 v49, v50, v51
    v_cvt_pk_bf16_f32 v50, v52, v53
    v_mfma_f32_16x16x32_bf16 v[112:115], v[184:187], v[192:195], v[112:115]
    v_cvt_pk_bf16_f32 v51, v54, v55
    v_pk_mul_f32 v[56:57], v[56:57], s[42:43]
    v_mfma_f32_16x16x32_bf16 v[120:123], v[188:191], v[192:195], v[120:123]
    v_pk_mul_f32 v[58:59], v[58:59], s[42:43]
    v_pk_mul_f32 v[60:61], v[60:61], s[42:43]
    s_waitcnt lgkmcnt(2)
    v_mfma_f32_16x16x32_bf16 v[100:103], v[176:179], v[196:199], v[100:103]
    v_pk_mul_f32 v[62:63], v[62:63], s[42:43]
    v_cvt_pk_bf16_f32 v56, v56, v57
    v_mfma_f32_16x16x32_bf16 v[108:111], v[180:183], v[196:199], v[108:111]
    v_cvt_pk_bf16_f32 v57, v58, v59
    v_cvt_pk_bf16_f32 v58, v60, v61
    v_mfma_f32_16x16x32_bf16 v[116:119], v[184:187], v[196:199], v[116:119]
    v_cvt_pk_bf16_f32 v59, v62, v63
    s_add_u32 s41, s41, s59
    v_mfma_f32_16x16x32_bf16 v[124:127], v[188:191], v[196:199], v[124:127]
    v_permlane16_swap_b32 v48, v50
    v_permlane16_swap_b32 v49, v51
    s_waitcnt lgkmcnt(1)
    v_mfma_f32_16x16x32_bf16 v[96:99], v[208:211], v[200:203], v[96:99]
    v_permlane16_swap_b32 v56, v58
    v_permlane16_swap_b32 v57, v59
    v_mfma_f32_16x16x32_bf16 v[104:107], v[212:215], v[200:203], v[104:107]
    buffer_store_dwordx4 v[48:51], v230, s[64:67], s41 offen offset:0 sc1
    buffer_store_dwordx4 v[56:59], v230, s[64:67], s41 offen offset:1024 sc1
    v_mfma_f32_16x16x32_bf16 v[112:115], v[216:219], v[200:203], v[112:115]
    v_mfma_f32_16x16x32_bf16 v[120:123], v[220:223], v[200:203], v[120:123]
    s_waitcnt lgkmcnt(0)
    v_mfma_f32_16x16x32_bf16 v[100:103], v[208:211], v[204:207], v[100:103]
    v_mfma_f32_16x16x32_bf16 v[108:111], v[212:215], v[204:207], v[108:111]
    v_mfma_f32_16x16x32_bf16 v[116:119], v[216:219], v[204:207], v[116:119]
    v_mfma_f32_16x16x32_bf16 v[124:127], v[220:223], v[204:207], v[124:127]
    s_nop 0
    s_nop 0
    s_nop 0
    s_nop 0
    s_nop 0
    v_pk_mul_f32 v[96:97], v[96:97], s[42:43]
    v_pk_mul_f32 v[98:99], v[98:99], s[42:43]
    v_pk_mul_f32 v[100:101], v[100:101], s[42:43]
    v_pk_mul_f32 v[102:103], v[102:103], s[42:43]
    v_cvt_pk_bf16_f32 v96, v96, v97
    v_cvt_pk_bf16_f32 v97, v98, v99
    v_cvt_pk_bf16_f32 v98, v100, v101
    v_cvt_pk_bf16_f32 v99, v102, v103
    v_pk_mul_f32 v[104:105], v[104:105], s[42:43]
    v_pk_mul_f32 v[106:107], v[106:107], s[42:43]
    v_pk_mul_f32 v[108:109], v[108:109], s[42:43]
    v_pk_mul_f32 v[110:111], v[110:111], s[42:43]
    v_cvt_pk_bf16_f32 v104, v104, v105
    v_cvt_pk_bf16_f32 v105, v106, v107
    v_cvt_pk_bf16_f32 v106, v108, v109
    v_cvt_pk_bf16_f32 v107, v110, v111
    s_mul_i32 s41, s60, 3
    s_add_u32 s41, s41, s58
    v_permlane16_swap_b32 v96, v98
    v_permlane16_swap_b32 v97, v99
    v_permlane16_swap_b32 v104, v106
    v_permlane16_swap_b32 v105, v107
    buffer_store_dwordx4 v[96:99], v230, s[64:67], s41 offen offset:0 sc1
    s_nop 0
    buffer_store_dwordx4 v[104:107], v230, s[64:67], s41 offen offset:1024 sc1
    v_pk_mul_f32 v[112:113], v[112:113], s[42:43]
    v_pk_mul_f32 v[114:115], v[114:115], s[42:43]
    v_pk_mul_f32 v[116:117], v[116:117], s[42:43]
    v_pk_mul_f32 v[118:119], v[118:119], s[42:43]
    v_cvt_pk_bf16_f32 v112, v112, v113
    v_cvt_pk_bf16_f32 v113, v114, v115
    v_cvt_pk_bf16_f32 v114, v116, v117
    v_cvt_pk_bf16_f32 v115, v118, v119
    v_pk_mul_f32 v[120:121], v[120:121], s[42:43]
    v_pk_mul_f32 v[122:123], v[122:123], s[42:43]
    v_pk_mul_f32 v[124:125], v[124:125], s[42:43]
    v_pk_mul_f32 v[126:127], v[126:127], s[42:43]
    v_cvt_pk_bf16_f32 v120, v120, v121
    v_cvt_pk_bf16_f32 v121, v122, v123
    v_cvt_pk_bf16_f32 v122, v124, v125
    v_cvt_pk_bf16_f32 v123, v126, v127
    s_add_u32 s41, s41, s59
    v_permlane16_swap_b32 v112, v114
    v_permlane16_swap_b32 v113, v115
    v_permlane16_swap_b32 v120, v122
    v_permlane16_swap_b32 v121, v123
    buffer_store_dwordx4 v[112:115], v230, s[64:67], s41 offen offset:0 sc1
    s_nop 0
    buffer_store_dwordx4 v[120:123], v230, s[64:67], s41 offen offset:1024 sc1
    s_branch p1_cdone
p1_end_q:
p1_ktype:
    s_cmp_lg_u32 s39, 0
    s_cbranch_scc1 p1_nopf_3
    s_getpc_b64 s[72:73]
pc_4:
    s_add_u32 s72, s72, p1_loop_k-pc_4
    s_addc_u32 s73, s73, 0
    v_lshlrev_b32 v248, 3, v230
    v_min_u32 v248, p1_end_k-p1_loop_k-4, v248
    v_and_b32 v248, -4, v248
    v_add_co_u32 v248, vcc, s72, v248
    v_mov_b32 v249, s73
    v_addc_co_u32 v249, vcc, 0, v249, vcc
    global_load_dword v250, v[248:249], off
p1_nopf_3:
    s_mov_b32 s58, 0
    s_cmp_eq_u32 s38, 1
    s_cselect_b32 s58, 4194304, s58
    s_cmp_eq_u32 s38, 2
    s_cselect_b32 s58, 4196352, s58
    s_cmp_eq_u32 s38, 3
    s_cselect_b32 s58, 12582912, s58
    s_add_u32 s41, s38, 1
    s_and_b32 s41, s41, 2
    s_cmp_eq_u32 s41, 0
    s_mov_b32 s44, 262144
    s_cselect_b32 s59, 131072, s44
    s_mov_b32 s44, 4096
    s_cselect_b32 s60, 2048, s44
    s_mov_b32 s44, 1.0
    s_cselect_b32 s42, 0x3e8293ee, s44
    s_mov_b32 s43, s42
    s_lshl_b32 s41, s37, 2
    s_and_b32 s44, s39, 2
    s_add_u32 s41, s41, s44
    s_mul_i32 s41, s41, s59
    s_add_u32 s58, s58, s41
    s_lshl_b32 s41, s36, 3
    s_and_b32 s44, s39, 1
    s_lshl_b32 s44, s44, 2
    s_add_u32 s41, s41, s44
    s_mul_i32 s41, s41, s60
    s_add_u32 s58, s58, s41
    s_mov_b32 s48, 13
    s_barrier
    ds_read_b64_tr_b16 v[160:161], v226 offset:0
    ds_read_b64_tr_b16 v[162:163], v226 offset:1024
    ds_read_b128 v[128:131], v224 offset:0
    ds_read_b64_tr_b16 v[164:165], v227 offset:0
    ds_read_b64_tr_b16 v[166:167], v227 offset:1024
    ds_read_b128 v[132:135], v224 offset:2048
    ds_read_b64_tr_b16 v[168:169], v228 offset:0
    ds_read_b64_tr_b16 v[170:171], v228 offset:1024
    ds_read_b64_tr_b16 v[172:173], v229 offset:0
    ds_read_b64_tr_b16 v[174:175], v229 offset:1024
    ds_read_b128 v[136:139], v224 offset:4096
    ds_read_b128 v[140:143], v224 offset:6144
    ds_read_b128 v[144:147], v224 offset:8192
    ds_read_b128 v[148:151], v224 offset:10240
    ds_read_b128 v[152:155], v224 offset:12288
    ds_read_b128 v[156:159], v224 offset:14336
p1_loop_k:
    s_waitcnt lgkmcnt(0)
    v_mfma_f32_16x16x32_bf16 v[0:3], v[160:163], v[128:131], v[0:3]
    ds_read_b64_tr_b16 v[208:209], v226 offset:8192
    v_mfma_f32_16x16x32_bf16 v[8:11], v[164:167], v[128:131], v[8:11]
    ds_read_b64_tr_b16 v[210:211], v226 offset:9216
    v_mfma_f32_16x16x32_bf16 v[16:19], v[168:171], v[128:131], v[16:19]
    ds_read_b128 v[176:179], v225 offset:0
    v_mfma_f32_16x16x32_bf16 v[24:27], v[172:175], v[128:131], v[24:27]
    ds_read_b64_tr_b16 v[212:213], v227 offset:8192
    v_mfma_f32_16x16x32_bf16 v[4:7], v[160:163], v[132:135], v[4:7]
    ds_read_b64_tr_b16 v[214:215], v227 offset:9216
    v_mfma_f32_16x16x32_bf16 v[12:15], v[164:167], v[132:135], v[12:15]
    ds_read_b128 v[180:183], v225 offset:2048
    v_mfma_f32_16x16x32_bf16 v[20:23], v[168:171], v[132:135], v[20:23]
    ds_read_b64_tr_b16 v[216:217], v228 offset:8192
    v_mfma_f32_16x16x32_bf16 v[28:31], v[172:175], v[132:135], v[28:31]
    ds_read_b64_tr_b16 v[218:219], v228 offset:9216
    v_mfma_f32_16x16x32_bf16 v[32:35], v[160:163], v[136:139], v[32:35]
    ds_read_b64_tr_b16 v[220:221], v229 offset:8192
    v_mfma_f32_16x16x32_bf16 v[40:43], v[164:167], v[136:139], v[40:43]
    ds_read_b64_tr_b16 v[222:223], v229 offset:9216
    v_mfma_f32_16x16x32_bf16 v[48:51], v[168:171], v[136:139], v[48:51]
    ds_read_b128 v[184:187], v225 offset:4096
    v_mfma_f32_16x16x32_bf16 v[56:59], v[172:175], v[136:139], v[56:59]
    ds_read_b128 v[188:191], v225 offset:6144
    v_mfma_f32_16x16x32_bf16 v[36:39], v[160:163], v[140:143], v[36:39]
    ds_read_b128 v[192:195], v225 offset:8192
    v_mfma_f32_16x16x32_bf16 v[44:47], v[164:167], v[140:143], v[44:47]
    ds_read_b128 v[196:199], v225 offset:10240
    v_mfma_f32_16x16x32_bf16 v[52:55], v[168:171], v[140:143], v[52:55]
    ds_read_b128 v[200:203], v225 offset:12288
    v_mfma_f32_16x16x32_bf16 v[60:63], v[172:175], v[140:143], v[60:63]
    ds_read_b128 v[204:207], v225 offset:14336
    v_mfma_f32_16x16x32_bf16 v[64:67], v[160:163], v[144:147], v[64:67]
    v_mfma_f32_16x16x32_bf16 v[72:75], v[164:167], v[144:147], v[72:75]
    v_mfma_f32_16x16x32_bf16 v[80:83], v[168:171], v[144:147], v[80:83]
    v_mfma_f32_16x16x32_bf16 v[88:91], v[172:175], v[144:147], v[88:91]
    v_mfma_f32_16x16x32_bf16 v[68:71], v[160:163], v[148:151], v[68:71]
    v_mfma_f32_16x16x32_bf16 v[76:79], v[164:167], v[148:151], v[76:79]
    v_mfma_f32_16x16x32_bf16 v[84:87], v[168:171], v[148:151], v[84:87]
    v_mfma_f32_16x16x32_bf16 v[92:95], v[172:175], v[148:151], v[92:95]
    v_mfma_f32_16x16x32_bf16 v[96:99], v[160:163], v[152:155], v[96:99]
    v_mfma_f32_16x16x32_bf16 v[104:107], v[164:167], v[152:155], v[104:107]
    v_mfma_f32_16x16x32_bf16 v[112:115], v[168:171], v[152:155], v[112:115]
    v_mfma_f32_16x16x32_bf16 v[120:123], v[172:175], v[152:155], v[120:123]
    v_mfma_f32_16x16x32_bf16 v[100:103], v[160:163], v[156:159], v[100:103]
    v_mfma_f32_16x16x32_bf16 v[108:111], v[164:167], v[156:159], v[108:111]
    v_mfma_f32_16x16x32_bf16 v[116:119], v[168:171], v[156:159], v[116:119]
    v_mfma_f32_16x16x32_bf16 v[124:127], v[172:175], v[156:159], v[124:127]
    s_waitcnt lgkmcnt(0)
    v_mfma_f32_16x16x32_bf16 v[0:3], v[208:211], v[176:179], v[0:3]
    v_mfma_f32_16x16x32_bf16 v[8:11], v[212:215], v[176:179], v[8:11]
    v_mfma_f32_16x16x32_bf16 v[16:19], v[216:219], v[176:179], v[16:19]
    v_mfma_f32_16x16x32_bf16 v[24:27], v[220:223], v[176:179], v[24:27]
    v_mfma_f32_16x16x32_bf16 v[4:7], v[208:211], v[180:183], v[4:7]
    v_mfma_f32_16x16x32_bf16 v[12:15], v[212:215], v[180:183], v[12:15]
    v_mfma_f32_16x16x32_bf16 v[20:23], v[216:219], v[180:183], v[20:23]
    v_mfma_f32_16x16x32_bf16 v[28:31], v[220:223], v[180:183], v[28:31]
    s_add_u32 s46, s46, 53248
    s_mov_b32 s47, 53248
    s_cmp_eq_u32 s46, 159744
    s_cselect_b32 s47, 4294860800, s47
    s_cselect_b32 s46, 0, s46
    v_add_u32 v224, s47, v224
    v_add_u32 v225, s47, v225
    v_add_u32 v226, s47, v226
    v_add_u32 v227, s47, v227
    v_add_u32 v228, s47, v228
    v_add_u32 v229, s47, v229
    s_barrier
    v_mfma_f32_16x16x32_bf16 v[32:35], v[208:211], v[184:187], v[32:35]
    ds_read_b64_tr_b16 v[160:161], v226 offset:0
    v_mfma_f32_16x16x32_bf16 v[40:43], v[212:215], v[184:187], v[40:43]
    ds_read_b64_tr_b16 v[162:163], v226 offset:1024
    v_mfma_f32_16x16x32_bf16 v[48:51], v[216:219], v[184:187], v[48:51]
    ds_read_b128 v[128:131], v224 offset:0
    v_mfma_f32_16x16x32_bf16 v[56:59], v[220:223], v[184:187], v[56:59]
    ds_read_b64_tr_b16 v[164:165], v227 offset:0
    v_mfma_f32_16x16x32_bf16 v[36:39], v[208:211], v[188:191], v[36:39]
    ds_read_b64_tr_b16 v[166:167], v227 offset:1024
    v_mfma_f32_16x16x32_bf16 v[44:47], v[212:215], v[188:191], v[44:47]
    ds_read_b128 v[132:135], v224 offset:2048
    v_mfma_f32_16x16x32_bf16 v[52:55], v[216:219], v[188:191], v[52:55]
    ds_read_b64_tr_b16 v[168:169], v228 offset:0
    v_mfma_f32_16x16x32_bf16 v[60:63], v[220:223], v[188:191], v[60:63]
    ds_read_b64_tr_b16 v[170:171], v228 offset:1024
    v_mfma_f32_16x16x32_bf16 v[64:67], v[208:211], v[192:195], v[64:67]
    ds_read_b64_tr_b16 v[172:173], v229 offset:0
    v_mfma_f32_16x16x32_bf16 v[72:75], v[212:215], v[192:195], v[72:75]
    ds_read_b64_tr_b16 v[174:175], v229 offset:1024
    v_mfma_f32_16x16x32_bf16 v[80:83], v[216:219], v[192:195], v[80:83]
    ds_read_b128 v[136:139], v224 offset:4096
    v_mfma_f32_16x16x32_bf16 v[88:91], v[220:223], v[192:195], v[88:91]
    ds_read_b128 v[140:143], v224 offset:6144
    v_mfma_f32_16x16x32_bf16 v[68:71], v[208:211], v[196:199], v[68:71]
    ds_read_b128 v[144:147], v224 offset:8192
    v_mfma_f32_16x16x32_bf16 v[76:79], v[212:215], v[196:199], v[76:79]
    ds_read_b128 v[148:151], v224 offset:10240
    v_mfma_f32_16x16x32_bf16 v[84:87], v[216:219], v[196:199], v[84:87]
    ds_read_b128 v[152:155], v224 offset:12288
    v_mfma_f32_16x16x32_bf16 v[92:95], v[220:223], v[196:199], v[92:95]
    ds_read_b128 v[156:159], v224 offset:14336
    v_mfma_f32_16x16x32_bf16 v[96:99], v[208:211], v[200:203], v[96:99]
    v_mfma_f32_16x16x32_bf16 v[104:107], v[212:215], v[200:203], v[104:107]
    v_mfma_f32_16x16x32_bf16 v[112:115], v[216:219], v[200:203], v[112:115]
    v_mfma_f32_16x16x32_bf16 v[120:123], v[220:223], v[200:203], v[120:123]
    v_mfma_f32_16x16x32_bf16 v[100:103], v[208:211], v[204:207], v[100:103]
    v_mfma_f32_16x16x32_bf16 v[108:111], v[212:215], v[204:207], v[108:111]
    v_mfma_f32_16x16x32_bf16 v[116:119], v[216:219], v[204:207], v[116:119]
    v_mfma_f32_16x16x32_bf16 v[124:127], v[220:223], v[204:207], v[124:127]
    s_sub_u32 s48, s48, 1
    s_cmp_lg_u32 s48, 0
    s_cbranch_scc1 p1_loop_k
    s_waitcnt lgkmcnt(0) vmcnt(0)
    v_mfma_f32_16x16x32_bf16 v[0:3], v[160:163], v[128:131], v[0:3]
    ds_read_b64_tr_b16 v[208:209], v226 offset:8192
    v_mfma_f32_16x16x32_bf16 v[8:11], v[164:167], v[128:131], v[8:11]
    ds_read_b64_tr_b16 v[210:211], v226 offset:9216
    v_mfma_f32_16x16x32_bf16 v[16:19], v[168:171], v[128:131], v[16:19]
    ds_read_b128 v[176:179], v225 offset:0
    v_mfma_f32_16x16x32_bf16 v[24:27], v[172:175], v[128:131], v[24:27]
    ds_read_b64_tr_b16 v[212:213], v227 offset:8192
    v_mfma_f32_16x16x32_bf16 v[4:7], v[160:163], v[132:135], v[4:7]
    ds_read_b64_tr_b16 v[214:215], v227 offset:9216
    v_mfma_f32_16x16x32_bf16 v[12:15], v[164:167], v[132:135], v[12:15]
    ds_read_b128 v[180:183], v225 offset:2048
    v_mfma_f32_16x16x32_bf16 v[20:23], v[168:171], v[132:135], v[20:23]
    ds_read_b64_tr_b16 v[216:217], v228 offset:8192
    v_mfma_f32_16x16x32_bf16 v[28:31], v[172:175], v[132:135], v[28:31]
    ds_read_b64_tr_b16 v[218:219], v228 offset:9216
    v_mfma_f32_16x16x32_bf16 v[32:35], v[160:163], v[136:139], v[32:35]
    ds_read_b64_tr_b16 v[220:221], v229 offset:8192
    v_mfma_f32_16x16x32_bf16 v[40:43], v[164:167], v[136:139], v[40:43]
    ds_read_b64_tr_b16 v[222:223], v229 offset:9216
    v_mfma_f32_16x16x32_bf16 v[48:51], v[168:171], v[136:139], v[48:51]
    ds_read_b128 v[184:187], v225 offset:4096
    v_mfma_f32_16x16x32_bf16 v[56:59], v[172:175], v[136:139], v[56:59]
    ds_read_b128 v[188:191], v225 offset:6144
    v_mfma_f32_16x16x32_bf16 v[36:39], v[160:163], v[140:143], v[36:39]
    ds_read_b128 v[192:195], v225 offset:8192
    v_mfma_f32_16x16x32_bf16 v[44:47], v[164:167], v[140:143], v[44:47]
    ds_read_b128 v[196:199], v225 offset:10240
    v_mfma_f32_16x16x32_bf16 v[52:55], v[168:171], v[140:143], v[52:55]
    ds_read_b128 v[200:203], v225 offset:12288
    v_mfma_f32_16x16x32_bf16 v[60:63], v[172:175], v[140:143], v[60:63]
    ds_read_b128 v[204:207], v225 offset:14336
    v_mfma_f32_16x16x32_bf16 v[64:67], v[160:163], v[144:147], v[64:67]
    v_mfma_f32_16x16x32_bf16 v[72:75], v[164:167], v[144:147], v[72:75]
    v_mfma_f32_16x16x32_bf16 v[80:83], v[168:171], v[144:147], v[80:83]
    v_mfma_f32_16x16x32_bf16 v[88:91], v[172:175], v[144:147], v[88:91]
    v_mfma_f32_16x16x32_bf16 v[68:71], v[160:163], v[148:151], v[68:71]
    v_mfma_f32_16x16x32_bf16 v[76:79], v[164:167], v[148:151], v[76:79]
    v_mfma_f32_16x16x32_bf16 v[84:87], v[168:171], v[148:151], v[84:87]
    v_mfma_f32_16x16x32_bf16 v[92:95], v[172:175], v[148:151], v[92:95]
    v_mfma_f32_16x16x32_bf16 v[96:99], v[160:163], v[152:155], v[96:99]
    v_mfma_f32_16x16x32_bf16 v[104:107], v[164:167], v[152:155], v[104:107]
    v_mfma_f32_16x16x32_bf16 v[112:115], v[168:171], v[152:155], v[112:115]
    v_mfma_f32_16x16x32_bf16 v[120:123], v[172:175], v[152:155], v[120:123]
    v_mfma_f32_16x16x32_bf16 v[100:103], v[160:163], v[156:159], v[100:103]
    v_mfma_f32_16x16x32_bf16 v[108:111], v[164:167], v[156:159], v[108:111]
    v_mfma_f32_16x16x32_bf16 v[116:119], v[168:171], v[156:159], v[116:119]
    v_mfma_f32_16x16x32_bf16 v[124:127], v[172:175], v[156:159], v[124:127]
    s_waitcnt lgkmcnt(0)
    v_mfma_f32_16x16x32_bf16 v[0:3], v[208:211], v[176:179], v[0:3]
    v_add_u32 v248, 4294914048, v224
    v_add_u32 v224, 53248, v224
    v_mfma_f32_16x16x32_bf16 v[8:11], v[212:215], v[176:179], v[8:11]
    v_add_u32 v249, 4294914048, v225
    v_add_u32 v225, 53248, v225
    v_mfma_f32_16x16x32_bf16 v[16:19], v[216:219], v[176:179], v[16:19]
    v_add_u32 v250, 4294914048, v226
    v_add_u32 v226, 53248, v226
    v_mfma_f32_16x16x32_bf16 v[24:27], v[220:223], v[176:179], v[24:27]
    v_add_u32 v251, 4294914048, v227
    v_add_u32 v227, 53248, v227
    v_mfma_f32_16x16x32_bf16 v[4:7], v[208:211], v[180:183], v[4:7]
    v_add_u32 v252, 4294914048, v228
    v_add_u32 v228, 53248, v228
    v_mfma_f32_16x16x32_bf16 v[12:15], v[212:215], v[180:183], v[12:15]
    v_add_u32 v253, 4294914048, v229
    v_add_u32 v229, 53248, v229
    v_mfma_f32_16x16x32_bf16 v[20:23], v[216:219], v[180:183], v[20:23]
    v_mfma_f32_16x16x32_bf16 v[28:31], v[220:223], v[180:183], v[28:31]
    s_barrier
    v_mfma_f32_16x16x32_bf16 v[32:35], v[208:211], v[184:187], v[32:35]
    ds_read_b64_tr_b16 v[160:161], v226 offset:0
    v_mfma_f32_16x16x32_bf16 v[40:43], v[212:215], v[184:187], v[40:43]
    ds_read_b64_tr_b16 v[162:163], v226 offset:1024
    v_mfma_f32_16x16x32_bf16 v[48:51], v[216:219], v[184:187], v[48:51]
    ds_read_b128 v[144:147], v224 offset:0
    v_mfma_f32_16x16x32_bf16 v[56:59], v[220:223], v[184:187], v[56:59]
    ds_read_b64_tr_b16 v[164:165], v227 offset:0
    v_mfma_f32_16x16x32_bf16 v[36:39], v[208:211], v[188:191], v[36:39]
    ds_read_b64_tr_b16 v[166:167], v227 offset:1024
    v_mfma_f32_16x16x32_bf16 v[44:47], v[212:215], v[188:191], v[44:47]
    ds_read_b128 v[148:151], v224 offset:2048
    v_mfma_f32_16x16x32_bf16 v[52:55], v[216:219], v[188:191], v[52:55]
    ds_read_b64_tr_b16 v[168:169], v228 offset:0
    v_mfma_f32_16x16x32_bf16 v[60:63], v[220:223], v[188:191], v[60:63]
    ds_read_b64_tr_b16 v[170:171], v228 offset:1024
    v_mfma_f32_16x16x32_bf16 v[64:67], v[208:211], v[192:195], v[64:67]
    ds_read_b64_tr_b16 v[172:173], v229 offset:0
    v_mfma_f32_16x16x32_bf16 v[72:75], v[212:215], v[192:195], v[72:75]
    ds_read_b64_tr_b16 v[174:175], v229 offset:1024
    v_mfma_f32_16x16x32_bf16 v[80:83], v[216:219], v[192:195], v[80:83]
    ds_read_b64_tr_b16 v[128:129], v226 offset:8192
    v_mfma_f32_16x16x32_bf16 v[88:91], v[220:223], v[192:195], v[88:91]
    ds_read_b64_tr_b16 v[130:131], v226 offset:9216
    v_mfma_f32_16x16x32_bf16 v[68:71], v[208:211], v[196:199], v[68:71]
    ds_read_b128 v[152:155], v225 offset:0
    v_mfma_f32_16x16x32_bf16 v[76:79], v[212:215], v[196:199], v[76:79]
    ds_read_b64_tr_b16 v[132:133], v227 offset:8192
    v_mfma_f32_16x16x32_bf16 v[84:87], v[216:219], v[196:199], v[84:87]
    ds_read_b64_tr_b16 v[134:135], v227 offset:9216
    v_mfma_f32_16x16x32_bf16 v[92:95], v[220:223], v[196:199], v[92:95]
    ds_read_b128 v[156:159], v225 offset:2048
    v_mfma_f32_16x16x32_bf16 v[96:99], v[208:211], v[200:203], v[96:99]
    ds_read_b64_tr_b16 v[136:137], v228 offset:8192
    v_mfma_f32_16x16x32_bf16 v[104:107], v[212:215], v[200:203], v[104:107]
    ds_read_b64_tr_b16 v[138:139], v228 offset:9216
    s_barrier
    v_mfma_f32_16x16x32_bf16 v[112:115], v[216:219], v[200:203], v[112:115]
    ds_read_b64_tr_b16 v[140:141], v229 offset:8192
    v_mfma_f32_16x16x32_bf16 v[120:123], v[220:223], v[200:203], v[120:123]
    ds_read_b64_tr_b16 v[142:143], v229 offset:9216
    v_mfma_f32_16x16x32_bf16 v[100:103], v[208:211], v[204:207], v[100:103]
    ds_read_b64_tr_b16 v[176:177], v250 offset:0
    v_mfma_f32_16x16x32_bf16 v[108:111], v[212:215], v[204:207], v[108:111]
    ds_read_b64_tr_b16 v[178:179], v250 offset:1024
    v_mfma_f32_16x16x32_bf16 v[116:119], v[216:219], v[204:207], v[116:119]
    ds_read_b64_tr_b16 v[180:181], v251 offset:0
    v_mfma_f32_16x16x32_bf16 v[124:127], v[220:223], v[204:207], v[124:127]
    ds_read_b64_tr_b16 v[182:183], v251 offset:1024
    s_waitcnt lgkmcnt(14)
    v_mfma_f32_16x16x32_bf16 v[0:3], v[160:163], v[144:147], v[0:3]
    ds_read_b64_tr_b16 v[184:185], v252 offset:0
    ds_read_b64_tr_b16 v[186:187], v252 offset:1024
    v_mfma_f32_16x16x32_bf16 v[8:11], v[164:167], v[144:147], v[8:11]
    ds_read_b64_tr_b16 v[188:189], v253 offset:0
    ds_read_b64_tr_b16 v[190:191], v253 offset:1024
    v_mfma_f32_16x16x32_bf16 v[16:19], v[168:171], v[144:147], v[16:19]
    ds_read_b128 v[192:195], v248 offset:0
    ds_read_b128 v[196:199], v248 offset:2048
    v_mfma_f32_16x16x32_bf16 v[24:27], v[172:175], v[144:147], v[24:27]
    ds_read_b64_tr_b16 v[208:209], v250 offset:8192
    ds_read_b64_tr_b16 v[210:211], v250 offset:9216
    v_mfma_f32_16x16x32_bf16 v[4:7], v[160:163], v[148:151], v[4:7]
    ds_read_b64_tr_b16 v[212:213], v251 offset:8192
    ds_read_b64_tr_b16 v[214:215], v251 offset:9216
    v_mfma_f32_16x16x32_bf16 v[12:15], v[164:167], v[148:151], v[12:15]
    ds_read_b64_tr_b16 v[216:217], v252 offset:8192
    ds_read_b64_tr_b16 v[218:219], v252 offset:9216
    v_mfma_f32_16x16x32_bf16 v[20:23], v[168:171], v[148:151], v[20:23]
    ds_read_b64_tr_b16 v[220:221], v253 offset:8192
    ds_read_b64_tr_b16 v[222:223], v253 offset:9216
    v_mfma_f32_16x16x32_bf16 v[28:31], v[172:175], v[148:151], v[28:31]
    ds_read_b128 v[200:203], v249 offset:0
    ds_read_b128 v[204:207], v249 offset:2048
    s_waitcnt lgkmcnt(15)
    v_mfma_f32_16x16x32_bf16 v[0:3], v[128:131], v[152:155], v[0:3]
    v_mfma_f32_16x16x32_bf16 v[8:11], v[132:135], v[152:155], v[8:11]
    v_mfma_f32_16x16x32_bf16 v[16:19], v[136:139], v[152:155], v[16:19]
    v_mfma_f32_16x16x32_bf16 v[24:27], v[140:143], v[152:155], v[24:27]
    v_mfma_f32_16x16x32_bf16 v[4:7], v[128:131], v[156:159], v[4:7]
    v_mfma_f32_16x16x32_bf16 v[12:15], v[132:135], v[156:159], v[12:15]
    v_mfma_f32_16x16x32_bf16 v[20:23], v[136:139], v[156:159], v[20:23]
    v_mfma_f32_16x16x32_bf16 v[28:31], v[140:143], v[156:159], v[28:31]
    s_waitcnt lgkmcnt(11)
    v_mfma_f32_16x16x32_bf16 v[0:3], v[176:179], v[192:195], v[0:3]
    ds_read_b128 v[144:147], v224 offset:8192
    ds_read_b128 v[148:151], v224 offset:10240
    v_mfma_f32_16x16x32_bf16 v[8:11], v[180:183], v[192:195], v[8:11]
    ds_read_b128 v[152:155], v225 offset:8192
    ds_read_b128 v[156:159], v225 offset:10240
    v_mfma_f32_16x16x32_bf16 v[16:19], v[184:187], v[192:195], v[16:19]
    v_mfma_f32_16x16x32_bf16 v[24:27], v[188:191], v[192:195], v[24:27]
    s_waitcnt lgkmcnt(14)
    v_mfma_f32_16x16x32_bf16 v[4:7], v[176:179], v[196:199], v[4:7]
    v_mfma_f32_16x16x32_bf16 v[12:15], v[180:183], v[196:199], v[12:15]
    v_mfma_f32_16x16x32_bf16 v[20:23], v[184:187], v[196:199], v[20:23]
    v_mfma_f32_16x16x32_bf16 v[28:31], v[188:191], v[196:199], v[28:31]
    s_waitcnt lgkmcnt(5)
    v_mfma_f32_16x16x32_bf16 v[0:3], v[208:211], v[200:203], v[0:3]
    v_mfma_f32_16x16x32_bf16 v[8:11], v[212:215], v[200:203], v[8:11]
    v_mfma_f32_16x16x32_bf16 v[16:19], v[216:219], v[200:203], v[16:19]
    v_mfma_f32_16x16x32_bf16 v[24:27], v[220:223], v[200:203], v[24:27]
    s_waitcnt lgkmcnt(4)
    v_mfma_f32_16x16x32_bf16 v[4:7], v[208:211], v[204:207], v[4:7]
    v_mfma_f32_16x16x32_bf16 v[12:15], v[212:215], v[204:207], v[12:15]
    v_mfma_f32_16x16x32_bf16 v[20:23], v[216:219], v[204:207], v[20:23]
    v_mfma_f32_16x16x32_bf16 v[28:31], v[220:223], v[204:207], v[28:31]
    s_waitcnt lgkmcnt(3)
    v_mfma_f32_16x16x32_bf16 v[64:67], v[160:163], v[144:147], v[64:67]
    ds_read_b128 v[192:195], v248 offset:8192
    v_mfma_f32_16x16x32_bf16 v[72:75], v[164:167], v[144:147], v[72:75]
    ds_read_b128 v[196:199], v248 offset:10240
    v_cvt_pk_bf16_f32 v0, v0, v1
    v_mfma_f32_16x16x32_bf16 v[80:83], v[168:171], v[144:147], v[80:83]
    ds_read_b128 v[200:203], v249 offset:8192
    v_cvt_pk_bf16_f32 v1, v2, v3
    v_mfma_f32_16x16x32_bf16 v[88:91], v[172:175], v[144:147], v[88:91]
    ds_read_b128 v[204:207], v249 offset:10240
    v_cvt_pk_bf16_f32 v2, v4, v5
    s_waitcnt lgkmcnt(6)
    v_mfma_f32_16x16x32_bf16 v[68:71], v[160:163], v[148:151], v[68:71]
    v_cvt_pk_bf16_f32 v3, v6, v7
    v_cvt_pk_bf16_f32 v8, v8, v9
    v_mfma_f32_16x16x32_bf16 v[76:79], v[164:167], v[148:151], v[76:79]
    v_cvt_pk_bf16_f32 v9, v10, v11
    v_cvt_pk_bf16_f32 v10, v12, v13
    v_mfma_f32_16x16x32_bf16 v[84:87], v[168:171], v[148:151], v[84:87]
    v_cvt_pk_bf16_f32 v11, v14, v15
    s_mov_b32 s41, s58
    v_mfma_f32_16x16x32_bf16 v[92:95], v[172:175], v[148:151], v[92:95]
    v_permlane16_swap_b32 v0, v2
    v_permlane16_swap_b32 v1, v3
    s_waitcnt lgkmcnt(5)
    v_mfma_f32_16x16x32_bf16 v[64:67], v[128:131], v[152:155], v[64:67]
    v_permlane16_swap_b32 v8, v10
    v_permlane16_swap_b32 v9, v11
    v_mfma_f32_16x16x32_bf16 v[72:75], v[132:135], v[152:155], v[72:75]
    buffer_store_dwordx4 v[0:3], v230, s[64:67], s41 offen offset:0 sc1
    buffer_store_dwordx4 v[8:11], v230, s[64:67], s41 offen offset:1024 sc1
    v_mfma_f32_16x16x32_bf16 v[80:83], v[136:139], v[152:155], v[80:83]
    v_cvt_pk_bf16_f32 v16, v16, v17
    v_cvt_pk_bf16_f32 v17, v18, v19
    v_mfma_f32_16x16x32_bf16 v[88:91], v[140:143], v[152:155], v[88:91]
    v_cvt_pk_bf16_f32 v18, v20, v21
    v_cvt_pk_bf16_f32 v19, v22, v23
    s_waitcnt lgkmcnt(4)
    v_mfma_f32_16x16x32_bf16 v[68:71], v[128:131], v[156:159], v[68:71]
    v_cvt_pk_bf16_f32 v24, v24, v25
    v_cvt_pk_bf16_f32 v25, v26, v27
    v_mfma_f32_16x16x32_bf16 v[76:79], v[132:135], v[156:159], v[76:79]
    v_cvt_pk_bf16_f32 v26, v28, v29
    v_cvt_pk_bf16_f32 v27, v30, v31
    v_mfma_f32_16x16x32_bf16 v[84:87], v[136:139], v[156:159], v[84:87]
    s_add_u32 s41, s41, s59
    v_permlane16_swap_b32 v16, v18
    v_mfma_f32_16x16x32_bf16 v[92:95], v[140:143], v[156:159], v[92:95]
    v_permlane16_swap_b32 v17, v19
    v_permlane16_swap_b32 v24, v26
    s_waitcnt lgkmcnt(3)
    v_mfma_f32_16x16x32_bf16 v[64:67], v[176:179], v[192:195], v[64:67]
    ds_read_b128 v[144:147], v224 offset:4096
    v_permlane16_swap_b32 v25, v27
    v_mfma_f32_16x16x32_bf16 v[72:75], v[180:183], v[192:195], v[72:75]
    ds_read_b128 v[148:151], v224 offset:6144
    buffer_store_dwordx4 v[16:19], v230, s[64:67], s41 offen offset:0 sc1
    v_mfma_f32_16x16x32_bf16 v[80:83], v[184:187], v[192:195], v[80:83]
    ds_read_b128 v[152:155], v225 offset:4096
    buffer_store_dwordx4 v[24:27], v230, s[64:67], s41 offen offset:1024 sc1
    v_mfma_f32_16x16x32_bf16 v[88:91], v[188:191], v[192:195], v[88:91]
    ds_read_b128 v[156:159], v225 offset:6144
    s_waitcnt lgkmcnt(6)
    v_mfma_f32_16x16x32_bf16 v[68:71], v[176:179], v[196:199], v[68:71]
    v_mfma_f32_16x16x32_bf16 v[76:79], v[180:183], v[196:199], v[76:79]
    v_mfma_f32_16x16x32_bf16 v[84:87], v[184:187], v[196:199], v[84:87]
    v_mfma_f32_16x16x32_bf16 v[92:95], v[188:191], v[196:199], v[92:95]
    s_waitcnt lgkmcnt(5)
    v_mfma_f32_16x16x32_bf16 v[64:67], v[208:211], v[200:203], v[64:67]
    v_mfma_f32_16x16x32_bf16 v[72:75], v[212:215], v[200:203], v[72:75]
    v_mfma_f32_16x16x32_bf16 v[80:83], v[216:219], v[200:203], v[80:83]
    v_mfma_f32_16x16x32_bf16 v[88:91], v[220:223], v[200:203], v[88:91]
    s_waitcnt lgkmcnt(4)
    v_mfma_f32_16x16x32_bf16 v[68:71], v[208:211], v[204:207], v[68:71]
    v_mfma_f32_16x16x32_bf16 v[76:79], v[212:215], v[204:207], v[76:79]
    v_mfma_f32_16x16x32_bf16 v[84:87], v[216:219], v[204:207], v[84:87]
    v_mfma_f32_16x16x32_bf16 v[92:95], v[220:223], v[204:207], v[92:95]
    s_barrier
    s_waitcnt lgkmcnt(3)
    v_mfma_f32_16x16x32_bf16 v[32:35], v[160:163], v[144:147], v[32:35]
    ds_read_b128 v[192:195], v248 offset:4096
    v_mfma_f32_16x16x32_bf16 v[40:43], v[164:167], v[144:147], v[40:43]
    ds_read_b128 v[196:199], v248 offset:6144
    v_cvt_pk_bf16_f32 v64, v64, v65
    v_mfma_f32_16x16x32_bf16 v[48:51], v[168:171], v[144:147], v[48:51]
    ds_read_b128 v[200:203], v249 offset:4096
    v_cvt_pk_bf16_f32 v65, v66, v67
    v_mfma_f32_16x16x32_bf16 v[56:59], v[172:175], v[144:147], v[56:59]
    ds_read_b128 v[204:207], v249 offset:6144
    v_cvt_pk_bf16_f32 v66, v68, v69
    s_waitcnt lgkmcnt(6)
    v_mfma_f32_16x16x32_bf16 v[36:39], v[160:163], v[148:151], v[36:39]
    v_cvt_pk_bf16_f32 v67, v70, v71
    v_cvt_pk_bf16_f32 v72, v72, v73
    v_mfma_f32_16x16x32_bf16 v[44:47], v[164:167], v[148:151], v[44:47]
    v_cvt_pk_bf16_f32 v73, v74, v75
    v_cvt_pk_bf16_f32 v74, v76, v77
    v_mfma_f32_16x16x32_bf16 v[52:55], v[168:171], v[148:151], v[52:55]
    v_cvt_pk_bf16_f32 v75, v78, v79
    s_mul_i32 s41, s60, 2
    v_mfma_f32_16x16x32_bf16 v[60:63], v[172:175], v[148:151], v[60:63]
    s_add_u32 s41, s41, s58
    v_permlane16_swap_b32 v64, v66
    s_waitcnt lgkmcnt(5)
    v_mfma_f32_16x16x32_bf16 v[32:35], v[128:131], v[152:155], v[32:35]
    v_permlane16_swap_b32 v65, v67
    v_permlane16_swap_b32 v72, v74
    v_mfma_f32_16x16x32_bf16 v[40:43], v[132:135], v[152:155], v[40:43]
    v_permlane16_swap_b32 v73, v75
    buffer_store_dwordx4 v[64:67], v230, s[64:67], s41 offen offset:0 sc1
    v_mfma_f32_16x16x32_bf16 v[48:51], v[136:139], v[152:155], v[48:51]
    buffer_store_dwordx4 v[72:75], v230, s[64:67], s41 offen offset:1024 sc1
    v_cvt_pk_bf16_f32 v80, v80, v81
    v_mfma_f32_16x16x32_bf16 v[56:59], v[140:143], v[152:155], v[56:59]
    v_cvt_pk_bf16_f32 v81, v82, v83
    v_cvt_pk_bf16_f32 v82, v84, v85
    s_waitcnt lgkmcnt(4)
    v_mfma_f32_16x16x32_bf16 v[36:39], v[128:131], v[156:159], v[36:39]
    v_cvt_pk_bf16_f32 v83, v86, v87
    v_cvt_pk_bf16_f32 v88, v88, v89
    v_mfma_f32_16x16x32_bf16 v[44:47], v[132:135], v[156:159], v[44:47]
    v_cvt_pk_bf16_f32 v89, v90, v91
    v_cvt_pk_bf16_f32 v90, v92, v93
    v_mfma_f32_16x16x32_bf16 v[52:55], v[136:139], v[156:159], v[52:55]
    v_cvt_pk_bf16_f32 v91, v94, v95
    s_add_u32 s41, s41, s59
    v_mfma_f32_16x16x32_bf16 v[60:63], v[140:143], v[156:159], v[60:63]
    v_permlane16_swap_b32 v80, v82
    v_permlane16_swap_b32 v81, v83
    s_waitcnt lgkmcnt(3)
    v_mfma_f32_16x16x32_bf16 v[32:35], v[176:179], v[192:195], v[32:35]
    ds_read_b128 v[144:147], v224 offset:12288
    v_permlane16_swap_b32 v88, v90
    v_mfma_f32_16x16x32_bf16 v[40:43], v[180:183], v[192:195], v[40:43]
    ds_read_b128 v[148:151], v224 offset:14336
    v_permlane16_swap_b32 v89, v91
    v_mfma_f32_16x16x32_bf16 v[48:51], v[184:187], v[192:195], v[48:51]
    ds_read_b128 v[152:155], v225 offset:12288
    buffer_store_dwordx4 v[80:83], v230, s[64:67], s41 offen offset:0 sc1
    v_mfma_f32_16x16x32_bf16 v[56:59], v[188:191], v[192:195], v[56:59]
    ds_read_b128 v[156:159], v225 offset:14336
    buffer_store_dwordx4 v[88:91], v230, s[64:67], s41 offen offset:1024 sc1
    s_waitcnt lgkmcnt(6)
    v_mfma_f32_16x16x32_bf16 v[36:39], v[176:179], v[196:199], v[36:39]
    v_mfma_f32_16x16x32_bf16 v[44:47], v[180:183], v[196:199], v[44:47]
    v_mfma_f32_16x16x32_bf16 v[52:55], v[184:187], v[196:199], v[52:55]
    v_mfma_f32_16x16x32_bf16 v[60:63], v[188:191], v[196:199], v[60:63]
    s_waitcnt lgkmcnt(5)
    v_mfma_f32_16x16x32_bf16 v[32:35], v[208:211], v[200:203], v[32:35]
    v_mfma_f32_16x16x32_bf16 v[40:43], v[212:215], v[200:203], v[40:43]
    v_mfma_f32_16x16x32_bf16 v[48:51], v[216:219], v[200:203], v[48:51]
    v_mfma_f32_16x16x32_bf16 v[56:59], v[220:223], v[200:203], v[56:59]
    s_waitcnt lgkmcnt(4)
    v_mfma_f32_16x16x32_bf16 v[36:39], v[208:211], v[204:207], v[36:39]
    v_mfma_f32_16x16x32_bf16 v[44:47], v[212:215], v[204:207], v[44:47]
    v_mfma_f32_16x16x32_bf16 v[52:55], v[216:219], v[204:207], v[52:55]
    v_mfma_f32_16x16x32_bf16 v[60:63], v[220:223], v[204:207], v[60:63]
    s_waitcnt lgkmcnt(3)
    v_mfma_f32_16x16x32_bf16 v[96:99], v[160:163], v[144:147], v[96:99]
    ds_read_b128 v[192:195], v248 offset:12288
    v_mfma_f32_16x16x32_bf16 v[104:107], v[164:167], v[144:147], v[104:107]
    ds_read_b128 v[196:199], v248 offset:14336
    v_cvt_pk_bf16_f32 v32, v32, v33
    v_mfma_f32_16x16x32_bf16 v[112:115], v[168:171], v[144:147], v[112:115]
    ds_read_b128 v[200:203], v249 offset:12288
    v_cvt_pk_bf16_f32 v33, v34, v35
    v_mfma_f32_16x16x32_bf16 v[120:123], v[172:175], v[144:147], v[120:123]
    ds_read_b128 v[204:207], v249 offset:14336
    v_cvt_pk_bf16_f32 v34, v36, v37
    s_waitcnt lgkmcnt(6)
    v_mfma_f32_16x16x32_bf16 v[100:103], v[160:163], v[148:151], v[100:103]
    v_cvt_pk_bf16_f32 v35, v38, v39
    v_cvt_pk_bf16_f32 v40, v40, v41
    v_mfma_f32_16x16x32_bf16 v[108:111], v[164:167], v[148:151], v[108:111]
    v_cvt_pk_bf16_f32 v41, v42, v43
    v_cvt_pk_bf16_f32 v42, v44, v45
    v_mfma_f32_16x16x32_bf16 v[116:119], v[168:171], v[148:151], v[116:119]
    v_cvt_pk_bf16_f32 v43, v46, v47
    s_mul_i32 s41, s60, 1
    v_mfma_f32_16x16x32_bf16 v[124:127], v[172:175], v[148:151], v[124:127]
    s_add_u32 s41, s41, s58
    v_permlane16_swap_b32 v32, v34
    s_waitcnt lgkmcnt(5)
    v_mfma_f32_16x16x32_bf16 v[96:99], v[128:131], v[152:155], v[96:99]
    v_permlane16_swap_b32 v33, v35
    v_permlane16_swap_b32 v40, v42
    v_mfma_f32_16x16x32_bf16 v[104:107], v[132:135], v[152:155], v[104:107]
    v_permlane16_swap_b32 v41, v43
    buffer_store_dwordx4 v[32:35], v230, s[64:67], s41 offen offset:0 sc1
    v_mfma_f32_16x16x32_bf16 v[112:115], v[136:139], v[152:155], v[112:115]
    buffer_store_dwordx4 v[40:43], v230, s[64:67], s41 offen offset:1024 sc1
    v_cvt_pk_bf16_f32 v48, v48, v49
    v_mfma_f32_16x16x32_bf16 v[120:123], v[140:143], v[152:155], v[120:123]
    v_cvt_pk_bf16_f32 v49, v50, v51
    v_cvt_pk_bf16_f32 v50, v52, v53
    s_waitcnt lgkmcnt(4)
    v_mfma_f32_16x16x32_bf16 v[100:103], v[128:131], v[156:159], v[100:103]
    v_cvt_pk_bf16_f32 v51, v54, v55
    v_cvt_pk_bf16_f32 v56, v56, v57
    v_mfma_f32_16x16x32_bf16 v[108:111], v[132:135], v[156:159], v[108:111]
    v_cvt_pk_bf16_f32 v57, v58, v59
    v_cvt_pk_bf16_f32 v58, v60, v61
    v_mfma_f32_16x16x32_bf16 v[116:119], v[136:139], v[156:159], v[116:119]
    v_cvt_pk_bf16_f32 v59, v62, v63
    s_add_u32 s41, s41, s59
    v_mfma_f32_16x16x32_bf16 v[124:127], v[140:143], v[156:159], v[124:127]
    v_permlane16_swap_b32 v48, v50
    v_permlane16_swap_b32 v49, v51
    s_waitcnt lgkmcnt(3)
    v_mfma_f32_16x16x32_bf16 v[96:99], v[176:179], v[192:195], v[96:99]
    v_permlane16_swap_b32 v56, v58
    v_permlane16_swap_b32 v57, v59
    v_mfma_f32_16x16x32_bf16 v[104:107], v[180:183], v[192:195], v[104:107]
    buffer_store_dwordx4 v[48:51], v230, s[64:67], s41 offen offset:0 sc1
    buffer_store_dwordx4 v[56:59], v230, s[64:67], s41 offen offset:1024 sc1
    v_mfma_f32_16x16x32_bf16 v[112:115], v[184:187], v[192:195], v[112:115]
    v_mfma_f32_16x16x32_bf16 v[120:123], v[188:191], v[192:195], v[120:123]
    s_waitcnt lgkmcnt(2)
    v_mfma_f32_16x16x32_bf16 v[100:103], v[176:179], v[196:199], v[100:103]
    v_mfma_f32_16x16x32_bf16 v[108:111], v[180:183], v[196:199], v[108:111]
    v_mfma_f32_16x16x32_bf16 v[116:119], v[184:187], v[196:199], v[116:119]
    v_mfma_f32_16x16x32_bf16 v[124:127], v[188:191], v[196:199], v[124:127]
    s_waitcnt lgkmcnt(1)
    v_mfma_f32_16x16x32_bf16 v[96:99], v[208:211], v[200:203], v[96:99]
    v_mfma_f32_16x16x32_bf16 v[104:107], v[212:215], v[200:203], v[104:107]
    v_mfma_f32_16x16x32_bf16 v[112:115], v[216:219], v[200:203], v[112:115]
    v_mfma_f32_16x16x32_bf16 v[120:123], v[220:223], v[200:203], v[120:123]
    s_waitcnt lgkmcnt(0)
    v_mfma_f32_16x16x32_bf16 v[100:103], v[208:211], v[204:207], v[100:103]
    v_mfma_f32_16x16x32_bf16 v[108:111], v[212:215], v[204:207], v[108:111]
    v_mfma_f32_16x16x32_bf16 v[116:119], v[216:219], v[204:207], v[116:119]
    v_mfma_f32_16x16x32_bf16 v[124:127], v[220:223], v[204:207], v[124:127]
    s_nop 0
    s_nop 0
    s_nop 0
    s_nop 0
    s_nop 0
    v_cvt_pk_bf16_f32 v96, v96, v97
    v_cvt_pk_bf16_f32 v97, v98, v99
    v_cvt_pk_bf16_f32 v98, v100, v101
    v_cvt_pk_bf16_f32 v99, v102, v103
    v_cvt_pk_bf16_f32 v104, v104, v105
    v_cvt_pk_bf16_f32 v105, v106, v107
    v_cvt_pk_bf16_f32 v106, v108, v109
    v_cvt_pk_bf16_f32 v107, v110, v111
    s_mul_i32 s41, s60, 3
    s_add_u32 s41, s41, s58
    v_permlane16_swap_b32 v96, v98
    v_permlane16_swap_b32 v97, v99
    v_permlane16_swap_b32 v104, v106
    v_permlane16_swap_b32 v105, v107
    buffer_store_dwordx4 v[96:99], v230, s[64:67], s41 offen offset:0 sc1
    s_nop 0
    buffer_store_dwordx4 v[104:107], v230, s[64:67], s41 offen offset:1024 sc1
    v_cvt_pk_bf16_f32 v112, v112, v113
    v_cvt_pk_bf16_f32 v113, v114, v115
    v_cvt_pk_bf16_f32 v114, v116, v117
    v_cvt_pk_bf16_f32 v115, v118, v119
    v_cvt_pk_bf16_f32 v120, v120, v121
    v_cvt_pk_bf16_f32 v121, v122, v123
    v_cvt_pk_bf16_f32 v122, v124, v125
    v_cvt_pk_bf16_f32 v123, v126, v127
    s_add_u32 s41, s41, s59
    v_permlane16_swap_b32 v112, v114
    v_permlane16_swap_b32 v113, v115
    v_permlane16_swap_b32 v120, v122
    v_permlane16_swap_b32 v121, v123
    buffer_store_dwordx4 v[112:115], v230, s[64:67], s41 offen offset:0 sc1
    s_nop 0
    buffer_store_dwordx4 v[120:123], v230, s[64:67], s41 offen offset:1024 sc1
    s_branch p1_cdone
p1_end_k:
p1_vtype:
    s_cmp_lg_u32 s39, 0
    s_cbranch_scc1 p1_nopf_5
    s_getpc_b64 s[72:73]
pc_6:
    s_add_u32 s72, s72, p1_loop_v-pc_6
    s_addc_u32 s73, s73, 0
    v_lshlrev_b32 v248, 3, v230
    v_min_u32 v248, p1_end_v-p1_loop_v-4, v248
    v_and_b32 v248, -4, v248
    v_add_co_u32 v248, vcc, s72, v248
    v_mov_b32 v249, s73
    v_addc_co_u32 v249, vcc, 0, v249, vcc
    global_load_dword v250, v[248:249], off
p1_nopf_5:
    s_mov_b32 s58, 0
    s_cmp_eq_u32 s38, 1
    s_cselect_b32 s58, 4194304, s58
    s_cmp_eq_u32 s38, 2
    s_cselect_b32 s58, 4196352, s58
    s_cmp_eq_u32 s38, 3
    s_cselect_b32 s58, 12582912, s58
    s_add_u32 s41, s38, 1
    s_and_b32 s41, s41, 2
    s_cmp_eq_u32 s41, 0
    s_mov_b32 s44, 262144
    s_cselect_b32 s59, 131072, s44
    s_mov_b32 s44, 4096
    s_cselect_b32 s60, 2048, s44
    s_mov_b32 s44, 1.0
    s_cselect_b32 s42, 0x3e8293ee, s44
    s_mov_b32 s43, s42
    s_lshl_b32 s41, s37, 2
    s_and_b32 s44, s39, 2
    s_add_u32 s41, s41, s44
    s_mul_i32 s41, s41, s59
    s_add_u32 s58, s58, s41
    s_lshl_b32 s41, s36, 3
    s_and_b32 s44, s39, 1
    s_lshl_b32 s44, s44, 2
    s_add_u32 s41, s41, s44
    s_mul_i32 s41, s41, s60
    s_add_u32 s58, s58, s41
    s_mov_b32 s48, 13
    s_barrier
    ds_read_b64_tr_b16 v[160:161], v226 offset:0
    ds_read_b64_tr_b16 v[162:163], v226 offset:1024
    ds_read_b128 v[128:131], v224 offset:0
    ds_read_b64_tr_b16 v[164:165], v227 offset:0
    ds_read_b64_tr_b16 v[166:167], v227 offset:1024
    ds_read_b128 v[132:135], v224 offset:2048
    ds_read_b64_tr_b16 v[168:169], v228 offset:0
    ds_read_b64_tr_b16 v[170:171], v228 offset:1024
    ds_read_b64_tr_b16 v[172:173], v229 offset:0
    ds_read_b64_tr_b16 v[174:175], v229 offset:1024
    ds_read_b128 v[136:139], v224 offset:4096
    ds_read_b128 v[140:143], v224 offset:6144
    ds_read_b128 v[144:147], v224 offset:8192
    ds_read_b128 v[148:151], v224 offset:10240
    ds_read_b128 v[152:155], v224 offset:12288
    ds_read_b128 v[156:159], v224 offset:14336
p1_loop_v:
    s_waitcnt lgkmcnt(0)
    v_mfma_f32_16x16x32_bf16 v[0:3], v[128:131], v[160:163], v[0:3]
    ds_read_b64_tr_b16 v[208:209], v226 offset:8192
    v_mfma_f32_16x16x32_bf16 v[4:7], v[128:131], v[164:167], v[4:7]
    ds_read_b64_tr_b16 v[210:211], v226 offset:9216
    v_mfma_f32_16x16x32_bf16 v[8:11], v[128:131], v[168:171], v[8:11]
    ds_read_b128 v[176:179], v225 offset:0
    v_mfma_f32_16x16x32_bf16 v[12:15], v[128:131], v[172:175], v[12:15]
    ds_read_b64_tr_b16 v[212:213], v227 offset:8192
    v_mfma_f32_16x16x32_bf16 v[16:19], v[132:135], v[160:163], v[16:19]
    ds_read_b64_tr_b16 v[214:215], v227 offset:9216
    v_mfma_f32_16x16x32_bf16 v[20:23], v[132:135], v[164:167], v[20:23]
    ds_read_b128 v[180:183], v225 offset:2048
    v_mfma_f32_16x16x32_bf16 v[24:27], v[132:135], v[168:171], v[24:27]
    ds_read_b64_tr_b16 v[216:217], v228 offset:8192
    v_mfma_f32_16x16x32_bf16 v[28:31], v[132:135], v[172:175], v[28:31]
    ds_read_b64_tr_b16 v[218:219], v228 offset:9216
    v_mfma_f32_16x16x32_bf16 v[32:35], v[136:139], v[160:163], v[32:35]
    ds_read_b64_tr_b16 v[220:221], v229 offset:8192
    v_mfma_f32_16x16x32_bf16 v[36:39], v[136:139], v[164:167], v[36:39]
    ds_read_b64_tr_b16 v[222:223], v229 offset:9216
    v_mfma_f32_16x16x32_bf16 v[40:43], v[136:139], v[168:171], v[40:43]
    ds_read_b128 v[184:187], v225 offset:4096
    v_mfma_f32_16x16x32_bf16 v[44:47], v[136:139], v[172:175], v[44:47]
    ds_read_b128 v[188:191], v225 offset:6144
    v_mfma_f32_16x16x32_bf16 v[48:51], v[140:143], v[160:163], v[48:51]
    ds_read_b128 v[192:195], v225 offset:8192
    v_mfma_f32_16x16x32_bf16 v[52:55], v[140:143], v[164:167], v[52:55]
    ds_read_b128 v[196:199], v225 offset:10240
    v_mfma_f32_16x16x32_bf16 v[56:59], v[140:143], v[168:171], v[56:59]
    ds_read_b128 v[200:203], v225 offset:12288
    v_mfma_f32_16x16x32_bf16 v[60:63], v[140:143], v[172:175], v[60:63]
    ds_read_b128 v[204:207], v225 offset:14336
    v_mfma_f32_16x16x32_bf16 v[64:67], v[144:147], v[160:163], v[64:67]
    v_mfma_f32_16x16x32_bf16 v[68:71], v[144:147], v[164:167], v[68:71]
    v_mfma_f32_16x16x32_bf16 v[72:75], v[144:147], v[168:171], v[72:75]
    v_mfma_f32_16x16x32_bf16 v[76:79], v[144:147], v[172:175], v[76:79]
    v_mfma_f32_16x16x32_bf16 v[80:83], v[148:151], v[160:163], v[80:83]
    v_mfma_f32_16x16x32_bf16 v[84:87], v[148:151], v[164:167], v[84:87]
    v_mfma_f32_16x16x32_bf16 v[88:91], v[148:151], v[168:171], v[88:91]
    v_mfma_f32_16x16x32_bf16 v[92:95], v[148:151], v[172:175], v[92:95]
    v_mfma_f32_16x16x32_bf16 v[96:99], v[152:155], v[160:163], v[96:99]
    v_mfma_f32_16x16x32_bf16 v[100:103], v[152:155], v[164:167], v[100:103]
    v_mfma_f32_16x16x32_bf16 v[104:107], v[152:155], v[168:171], v[104:107]
    v_mfma_f32_16x16x32_bf16 v[108:111], v[152:155], v[172:175], v[108:111]
    v_mfma_f32_16x16x32_bf16 v[112:115], v[156:159], v[160:163], v[112:115]
    v_mfma_f32_16x16x32_bf16 v[116:119], v[156:159], v[164:167], v[116:119]
    v_mfma_f32_16x16x32_bf16 v[120:123], v[156:159], v[168:171], v[120:123]
    v_mfma_f32_16x16x32_bf16 v[124:127], v[156:159], v[172:175], v[124:127]
    s_waitcnt lgkmcnt(0)
    v_mfma_f32_16x16x32_bf16 v[0:3], v[176:179], v[208:211], v[0:3]
    v_mfma_f32_16x16x32_bf16 v[4:7], v[176:179], v[212:215], v[4:7]
    v_mfma_f32_16x16x32_bf16 v[8:11], v[176:179], v[216:219], v[8:11]
    v_mfma_f32_16x16x32_bf16 v[12:15], v[176:179], v[220:223], v[12:15]
    v_mfma_f32_16x16x32_bf16 v[16:19], v[180:183], v[208:211], v[16:19]
    v_mfma_f32_16x16x32_bf16 v[20:23], v[180:183], v[212:215], v[20:23]
    v_mfma_f32_16x16x32_bf16 v[24:27], v[180:183], v[216:219], v[24:27]
    v_mfma_f32_16x16x32_bf16 v[28:31], v[180:183], v[220:223], v[28:31]
    s_add_u32 s46, s46, 53248
    s_mov_b32 s47, 53248
    s_cmp_eq_u32 s46, 159744
    s_cselect_b32 s47, 4294860800, s47
    s_cselect_b32 s46, 0, s46
    v_add_u32 v224, s47, v224
    v_add_u32 v225, s47, v225
    v_add_u32 v226, s47, v226
    v_add_u32 v227, s47, v227
    v_add_u32 v228, s47, v228
    v_add_u32 v229, s47, v229
    s_barrier
    v_mfma_f32_16x16x32_bf16 v[32:35], v[184:187], v[208:211], v[32:35]
    ds_read_b64_tr_b16 v[160:161], v226 offset:0
    v_mfma_f32_16x16x32_bf16 v[36:39], v[184:187], v[212:215], v[36:39]
    ds_read_b64_tr_b16 v[162:163], v226 offset:1024
    v_mfma_f32_16x16x32_bf16 v[40:43], v[184:187], v[216:219], v[40:43]
    ds_read_b128 v[128:131], v224 offset:0
    v_mfma_f32_16x16x32_bf16 v[44:47], v[184:187], v[220:223], v[44:47]
    ds_read_b64_tr_b16 v[164:165], v227 offset:0
    v_mfma_f32_16x16x32_bf16 v[48:51], v[188:191], v[208:211], v[48:51]
    ds_read_b64_tr_b16 v[166:167], v227 offset:1024
    v_mfma_f32_16x16x32_bf16 v[52:55], v[188:191], v[212:215], v[52:55]
    ds_read_b128 v[132:135], v224 offset:2048
    v_mfma_f32_16x16x32_bf16 v[56:59], v[188:191], v[216:219], v[56:59]
    ds_read_b64_tr_b16 v[168:169], v228 offset:0
    v_mfma_f32_16x16x32_bf16 v[60:63], v[188:191], v[220:223], v[60:63]
    ds_read_b64_tr_b16 v[170:171], v228 offset:1024
    v_mfma_f32_16x16x32_bf16 v[64:67], v[192:195], v[208:211], v[64:67]
    ds_read_b64_tr_b16 v[172:173], v229 offset:0
    v_mfma_f32_16x16x32_bf16 v[68:71], v[192:195], v[212:215], v[68:71]
    ds_read_b64_tr_b16 v[174:175], v229 offset:1024
    v_mfma_f32_16x16x32_bf16 v[72:75], v[192:195], v[216:219], v[72:75]
    ds_read_b128 v[136:139], v224 offset:4096
    v_mfma_f32_16x16x32_bf16 v[76:79], v[192:195], v[220:223], v[76:79]
    ds_read_b128 v[140:143], v224 offset:6144
    v_mfma_f32_16x16x32_bf16 v[80:83], v[196:199], v[208:211], v[80:83]
    ds_read_b128 v[144:147], v224 offset:8192
    v_mfma_f32_16x16x32_bf16 v[84:87], v[196:199], v[212:215], v[84:87]
    ds_read_b128 v[148:151], v224 offset:10240
    v_mfma_f32_16x16x32_bf16 v[88:91], v[196:199], v[216:219], v[88:91]
    ds_read_b128 v[152:155], v224 offset:12288
    v_mfma_f32_16x16x32_bf16 v[92:95], v[196:199], v[220:223], v[92:95]
    ds_read_b128 v[156:159], v224 offset:14336
    v_mfma_f32_16x16x32_bf16 v[96:99], v[200:203], v[208:211], v[96:99]
    v_mfma_f32_16x16x32_bf16 v[100:103], v[200:203], v[212:215], v[100:103]
    v_mfma_f32_16x16x32_bf16 v[104:107], v[200:203], v[216:219], v[104:107]
    v_mfma_f32_16x16x32_bf16 v[108:111], v[200:203], v[220:223], v[108:111]
    v_mfma_f32_16x16x32_bf16 v[112:115], v[204:207], v[208:211], v[112:115]
    v_mfma_f32_16x16x32_bf16 v[116:119], v[204:207], v[212:215], v[116:119]
    v_mfma_f32_16x16x32_bf16 v[120:123], v[204:207], v[216:219], v[120:123]
    v_mfma_f32_16x16x32_bf16 v[124:127], v[204:207], v[220:223], v[124:127]
    s_sub_u32 s48, s48, 1
    s_cmp_lg_u32 s48, 0
    s_cbranch_scc1 p1_loop_v
    s_waitcnt lgkmcnt(0) vmcnt(0)
    v_mfma_f32_16x16x32_bf16 v[0:3], v[128:131], v[160:163], v[0:3]
    ds_read_b64_tr_b16 v[208:209], v226 offset:8192
    v_mfma_f32_16x16x32_bf16 v[4:7], v[128:131], v[164:167], v[4:7]
    ds_read_b64_tr_b16 v[210:211], v226 offset:9216
    v_mfma_f32_16x16x32_bf16 v[8:11], v[128:131], v[168:171], v[8:11]
    ds_read_b128 v[176:179], v225 offset:0
    v_mfma_f32_16x16x32_bf16 v[12:15], v[128:131], v[172:175], v[12:15]
    ds_read_b64_tr_b16 v[212:213], v227 offset:8192
    v_mfma_f32_16x16x32_bf16 v[16:19], v[132:135], v[160:163], v[16:19]
    ds_read_b64_tr_b16 v[214:215], v227 offset:9216
    v_mfma_f32_16x16x32_bf16 v[20:23], v[132:135], v[164:167], v[20:23]
    ds_read_b128 v[180:183], v225 offset:2048
    v_mfma_f32_16x16x32_bf16 v[24:27], v[132:135], v[168:171], v[24:27]
    ds_read_b64_tr_b16 v[216:217], v228 offset:8192
    v_mfma_f32_16x16x32_bf16 v[28:31], v[132:135], v[172:175], v[28:31]
    ds_read_b64_tr_b16 v[218:219], v228 offset:9216
    v_mfma_f32_16x16x32_bf16 v[32:35], v[136:139], v[160:163], v[32:35]
    ds_read_b64_tr_b16 v[220:221], v229 offset:8192
    v_mfma_f32_16x16x32_bf16 v[36:39], v[136:139], v[164:167], v[36:39]
    ds_read_b64_tr_b16 v[222:223], v229 offset:9216
    v_mfma_f32_16x16x32_bf16 v[40:43], v[136:139], v[168:171], v[40:43]
    ds_read_b128 v[184:187], v225 offset:4096
    v_mfma_f32_16x16x32_bf16 v[44:47], v[136:139], v[172:175], v[44:47]
    ds_read_b128 v[188:191], v225 offset:6144
    v_mfma_f32_16x16x32_bf16 v[48:51], v[140:143], v[160:163], v[48:51]
    ds_read_b128 v[192:195], v225 offset:8192
    v_mfma_f32_16x16x32_bf16 v[52:55], v[140:143], v[164:167], v[52:55]
    ds_read_b128 v[196:199], v225 offset:10240
    v_mfma_f32_16x16x32_bf16 v[56:59], v[140:143], v[168:171], v[56:59]
    ds_read_b128 v[200:203], v225 offset:12288
    v_mfma_f32_16x16x32_bf16 v[60:63], v[140:143], v[172:175], v[60:63]
    ds_read_b128 v[204:207], v225 offset:14336
    v_mfma_f32_16x16x32_bf16 v[64:67], v[144:147], v[160:163], v[64:67]
    v_mfma_f32_16x16x32_bf16 v[68:71], v[144:147], v[164:167], v[68:71]
    v_mfma_f32_16x16x32_bf16 v[72:75], v[144:147], v[168:171], v[72:75]
    v_mfma_f32_16x16x32_bf16 v[76:79], v[144:147], v[172:175], v[76:79]
    v_mfma_f32_16x16x32_bf16 v[80:83], v[148:151], v[160:163], v[80:83]
    v_mfma_f32_16x16x32_bf16 v[84:87], v[148:151], v[164:167], v[84:87]
    v_mfma_f32_16x16x32_bf16 v[88:91], v[148:151], v[168:171], v[88:91]
    v_mfma_f32_16x16x32_bf16 v[92:95], v[148:151], v[172:175], v[92:95]
    v_mfma_f32_16x16x32_bf16 v[96:99], v[152:155], v[160:163], v[96:99]
    v_mfma_f32_16x16x32_bf16 v[100:103], v[152:155], v[164:167], v[100:103]
    v_mfma_f32_16x16x32_bf16 v[104:107], v[152:155], v[168:171], v[104:107]
    v_mfma_f32_16x16x32_bf16 v[108:111], v[152:155], v[172:175], v[108:111]
    v_mfma_f32_16x16x32_bf16 v[112:115], v[156:159], v[160:163], v[112:115]
    v_mfma_f32_16x16x32_bf16 v[116:119], v[156:159], v[164:167], v[116:119]
    v_mfma_f32_16x16x32_bf16 v[120:123], v[156:159], v[168:171], v[120:123]
    v_mfma_f32_16x16x32_bf16 v[124:127], v[156:159], v[172:175], v[124:127]
    s_waitcnt lgkmcnt(0)
    v_mfma_f32_16x16x32_bf16 v[0:3], v[176:179], v[208:211], v[0:3]
    v_add_u32 v248, 4294914048, v224
    v_add_u32 v224, 53248, v224
    v_mfma_f32_16x16x32_bf16 v[4:7], v[176:179], v[212:215], v[4:7]
    v_add_u32 v249, 4294914048, v225
    v_add_u32 v225, 53248, v225
    v_mfma_f32_16x16x32_bf16 v[8:11], v[176:179], v[216:219], v[8:11]
    v_add_u32 v250, 4294914048, v226
    v_add_u32 v226, 53248, v226
    v_mfma_f32_16x16x32_bf16 v[12:15], v[176:179], v[220:223], v[12:15]
    v_add_u32 v251, 4294914048, v227
    v_add_u32 v227, 53248, v227
    v_mfma_f32_16x16x32_bf16 v[16:19], v[180:183], v[208:211], v[16:19]
    v_add_u32 v252, 4294914048, v228
    v_add_u32 v228, 53248, v228
    v_mfma_f32_16x16x32_bf16 v[20:23], v[180:183], v[212:215], v[20:23]
    v_add_u32 v253, 4294914048, v229
    v_add_u32 v229, 53248, v229
    v_mfma_f32_16x16x32_bf16 v[24:27], v[180:183], v[216:219], v[24:27]
    v_mfma_f32_16x16x32_bf16 v[28:31], v[180:183], v[220:223], v[28:31]
    s_barrier
    v_mfma_f32_16x16x32_bf16 v[32:35], v[184:187], v[208:211], v[32:35]
    ds_read_b64_tr_b16 v[160:161], v226 offset:0
    v_mfma_f32_16x16x32_bf16 v[36:39], v[184:187], v[212:215], v[36:39]
    ds_read_b64_tr_b16 v[162:163], v226 offset:1024
    v_mfma_f32_16x16x32_bf16 v[40:43], v[184:187], v[216:219], v[40:43]
    ds_read_b128 v[144:147], v224 offset:0
    v_mfma_f32_16x16x32_bf16 v[44:47], v[184:187], v[220:223], v[44:47]
    ds_read_b64_tr_b16 v[164:165], v227 offset:0
    v_mfma_f32_16x16x32_bf16 v[48:51], v[188:191], v[208:211], v[48:51]
    ds_read_b64_tr_b16 v[166:167], v227 offset:1024
    v_mfma_f32_16x16x32_bf16 v[52:55], v[188:191], v[212:215], v[52:55]
    ds_read_b128 v[148:151], v224 offset:2048
    v_mfma_f32_16x16x32_bf16 v[56:59], v[188:191], v[216:219], v[56:59]
    ds_read_b64_tr_b16 v[168:169], v228 offset:0
    v_mfma_f32_16x16x32_bf16 v[60:63], v[188:191], v[220:223], v[60:63]
    ds_read_b64_tr_b16 v[170:171], v228 offset:1024
    v_mfma_f32_16x16x32_bf16 v[64:67], v[192:195], v[208:211], v[64:67]
    ds_read_b64_tr_b16 v[172:173], v229 offset:0
    v_mfma_f32_16x16x32_bf16 v[68:71], v[192:195], v[212:215], v[68:71]
    ds_read_b64_tr_b16 v[174:175], v229 offset:1024
    v_mfma_f32_16x16x32_bf16 v[72:75], v[192:195], v[216:219], v[72:75]
    ds_read_b64_tr_b16 v[128:129], v226 offset:8192
    v_mfma_f32_16x16x32_bf16 v[76:79], v[192:195], v[220:223], v[76:79]
    ds_read_b64_tr_b16 v[130:131], v226 offset:9216
    v_mfma_f32_16x16x32_bf16 v[80:83], v[196:199], v[208:211], v[80:83]
    ds_read_b128 v[152:155], v225 offset:0
    v_mfma_f32_16x16x32_bf16 v[84:87], v[196:199], v[212:215], v[84:87]
    ds_read_b64_tr_b16 v[132:133], v227 offset:8192
    v_mfma_f32_16x16x32_bf16 v[88:91], v[196:199], v[216:219], v[88:91]
    ds_read_b64_tr_b16 v[134:135], v227 offset:9216
    v_mfma_f32_16x16x32_bf16 v[92:95], v[196:199], v[220:223], v[92:95]
    ds_read_b128 v[156:159], v225 offset:2048
    v_mfma_f32_16x16x32_bf16 v[96:99], v[200:203], v[208:211], v[96:99]
    ds_read_b64_tr_b16 v[136:137], v228 offset:8192
    v_mfma_f32_16x16x32_bf16 v[100:103], v[200:203], v[212:215], v[100:103]
    ds_read_b64_tr_b16 v[138:139], v228 offset:9216
    s_barrier
    v_mfma_f32_16x16x32_bf16 v[104:107], v[200:203], v[216:219], v[104:107]
    ds_read_b64_tr_b16 v[140:141], v229 offset:8192
    v_mfma_f32_16x16x32_bf16 v[108:111], v[200:203], v[220:223], v[108:111]
    ds_read_b64_tr_b16 v[142:143], v229 offset:9216
    v_mfma_f32_16x16x32_bf16 v[112:115], v[204:207], v[208:211], v[112:115]
    ds_read_b64_tr_b16 v[176:177], v250 offset:0
    v_mfma_f32_16x16x32_bf16 v[116:119], v[204:207], v[212:215], v[116:119]
    ds_read_b64_tr_b16 v[178:179], v250 offset:1024
    v_mfma_f32_16x16x32_bf16 v[120:123], v[204:207], v[216:219], v[120:123]
    ds_read_b64_tr_b16 v[180:181], v251 offset:0
    v_mfma_f32_16x16x32_bf16 v[124:127], v[204:207], v[220:223], v[124:127]
    ds_read_b64_tr_b16 v[182:183], v251 offset:1024
    s_waitcnt lgkmcnt(14)
    v_mfma_f32_16x16x32_bf16 v[0:3], v[144:147], v[160:163], v[0:3]
    ds_read_b64_tr_b16 v[184:185], v252 offset:0
    ds_read_b64_tr_b16 v[186:187], v252 offset:1024
    v_mfma_f32_16x16x32_bf16 v[4:7], v[144:147], v[164:167], v[4:7]
    ds_read_b64_tr_b16 v[188:189], v253 offset:0
    ds_read_b64_tr_b16 v[190:191], v253 offset:1024
    v_mfma_f32_16x16x32_bf16 v[8:11], v[144:147], v[168:171], v[8:11]
    ds_read_b128 v[192:195], v248 offset:0
    ds_read_b128 v[196:199], v248 offset:2048
    v_mfma_f32_16x16x32_bf16 v[12:15], v[144:147], v[172:175], v[12:15]
    ds_read_b64_tr_b16 v[208:209], v250 offset:8192
    ds_read_b64_tr_b16 v[210:211], v250 offset:9216
    v_mfma_f32_16x16x32_bf16 v[16:19], v[148:151], v[160:163], v[16:19]
    ds_read_b64_tr_b16 v[212:213], v251 offset:8192
    ds_read_b64_tr_b16 v[214:215], v251 offset:9216
    v_mfma_f32_16x16x32_bf16 v[20:23], v[148:151], v[164:167], v[20:23]
    ds_read_b64_tr_b16 v[216:217], v252 offset:8192
    ds_read_b64_tr_b16 v[218:219], v252 offset:9216
    v_mfma_f32_16x16x32_bf16 v[24:27], v[148:151], v[168:171], v[24:27]
    ds_read_b64_tr_b16 v[220:221], v253 offset:8192
    ds_read_b64_tr_b16 v[222:223], v253 offset:9216
    v_mfma_f32_16x16x32_bf16 v[28:31], v[148:151], v[172:175], v[28:31]
    ds_read_b128 v[200:203], v249 offset:0
    ds_read_b128 v[204:207], v249 offset:2048
    s_waitcnt lgkmcnt(15)
    v_mfma_f32_16x16x32_bf16 v[0:3], v[152:155], v[128:131], v[0:3]
    v_mfma_f32_16x16x32_bf16 v[4:7], v[152:155], v[132:135], v[4:7]
    v_mfma_f32_16x16x32_bf16 v[8:11], v[152:155], v[136:139], v[8:11]
    v_mfma_f32_16x16x32_bf16 v[12:15], v[152:155], v[140:143], v[12:15]
    v_mfma_f32_16x16x32_bf16 v[16:19], v[156:159], v[128:131], v[16:19]
    v_mfma_f32_16x16x32_bf16 v[20:23], v[156:159], v[132:135], v[20:23]
    v_mfma_f32_16x16x32_bf16 v[24:27], v[156:159], v[136:139], v[24:27]
    v_mfma_f32_16x16x32_bf16 v[28:31], v[156:159], v[140:143], v[28:31]
    s_waitcnt lgkmcnt(11)
    v_mfma_f32_16x16x32_bf16 v[0:3], v[192:195], v[176:179], v[0:3]
    ds_read_b128 v[144:147], v224 offset:8192
    ds_read_b128 v[148:151], v224 offset:10240
    v_mfma_f32_16x16x32_bf16 v[4:7], v[192:195], v[180:183], v[4:7]
    ds_read_b128 v[152:155], v225 offset:8192
    ds_read_b128 v[156:159], v225 offset:10240
    v_mfma_f32_16x16x32_bf16 v[8:11], v[192:195], v[184:187], v[8:11]
    v_mfma_f32_16x16x32_bf16 v[12:15], v[192:195], v[188:191], v[12:15]
    s_waitcnt lgkmcnt(14)
    v_mfma_f32_16x16x32_bf16 v[16:19], v[196:199], v[176:179], v[16:19]
    v_mfma_f32_16x16x32_bf16 v[20:23], v[196:199], v[180:183], v[20:23]
    v_mfma_f32_16x16x32_bf16 v[24:27], v[196:199], v[184:187], v[24:27]
    v_mfma_f32_16x16x32_bf16 v[28:31], v[196:199], v[188:191], v[28:31]
    s_waitcnt lgkmcnt(5)
    v_mfma_f32_16x16x32_bf16 v[0:3], v[200:203], v[208:211], v[0:3]
    v_mfma_f32_16x16x32_bf16 v[4:7], v[200:203], v[212:215], v[4:7]
    v_mfma_f32_16x16x32_bf16 v[8:11], v[200:203], v[216:219], v[8:11]
    v_mfma_f32_16x16x32_bf16 v[12:15], v[200:203], v[220:223], v[12:15]
    s_waitcnt lgkmcnt(4)
    v_mfma_f32_16x16x32_bf16 v[16:19], v[204:207], v[208:211], v[16:19]
    v_mfma_f32_16x16x32_bf16 v[20:23], v[204:207], v[212:215], v[20:23]
    v_mfma_f32_16x16x32_bf16 v[24:27], v[204:207], v[216:219], v[24:27]
    v_mfma_f32_16x16x32_bf16 v[28:31], v[204:207], v[220:223], v[28:31]
    s_waitcnt lgkmcnt(3)
    v_mfma_f32_16x16x32_bf16 v[64:67], v[144:147], v[160:163], v[64:67]
    ds_read_b128 v[192:195], v248 offset:8192
    v_cvt_pk_bf16_f32 v0, v0, v1
    v_mfma_f32_16x16x32_bf16 v[68:71], v[144:147], v[164:167], v[68:71]
    ds_read_b128 v[196:199], v248 offset:10240
    v_cvt_pk_bf16_f32 v1, v2, v3
    v_mfma_f32_16x16x32_bf16 v[72:75], v[144:147], v[168:171], v[72:75]
    ds_read_b128 v[200:203], v249 offset:8192
    v_cvt_pk_bf16_f32 v2, v4, v5
    v_mfma_f32_16x16x32_bf16 v[76:79], v[144:147], v[172:175], v[76:79]
    ds_read_b128 v[204:207], v249 offset:10240
    v_cvt_pk_bf16_f32 v3, v6, v7
    s_waitcnt lgkmcnt(6)
    v_mfma_f32_16x16x32_bf16 v[80:83], v[148:151], v[160:163], v[80:83]
    v_cvt_pk_bf16_f32 v16, v16, v17
    v_cvt_pk_bf16_f32 v17, v18, v19
    v_mfma_f32_16x16x32_bf16 v[84:87], v[148:151], v[164:167], v[84:87]
    v_cvt_pk_bf16_f32 v18, v20, v21
    v_cvt_pk_bf16_f32 v19, v22, v23
    v_mfma_f32_16x16x32_bf16 v[88:91], v[148:151], v[168:171], v[88:91]
    s_mov_b32 s41, s58
    v_permlane16_swap_b32 v0, v2
    v_mfma_f32_16x16x32_bf16 v[92:95], v[148:151], v[172:175], v[92:95]
    v_permlane16_swap_b32 v1, v3
    v_permlane16_swap_b32 v16, v18
    s_waitcnt lgkmcnt(5)
    v_mfma_f32_16x16x32_bf16 v[64:67], v[152:155], v[128:131], v[64:67]
    v_permlane16_swap_b32 v17, v19
    buffer_store_dwordx4 v[0:3], v230, s[64:67], s41 offen offset:0 sc1
    v_mfma_f32_16x16x32_bf16 v[68:71], v[152:155], v[132:135], v[68:71]
    buffer_store_dwordx4 v[16:19], v230, s[64:67], s41 offen offset:1024 sc1
    v_cvt_pk_bf16_f32 v8, v8, v9
    v_mfma_f32_16x16x32_bf16 v[72:75], v[152:155], v[136:139], v[72:75]
    v_cvt_pk_bf16_f32 v9, v10, v11
    v_cvt_pk_bf16_f32 v10, v12, v13
    v_mfma_f32_16x16x32_bf16 v[76:79], v[152:155], v[140:143], v[76:79]
    v_cvt_pk_bf16_f32 v11, v14, v15
    v_cvt_pk_bf16_f32 v24, v24, v25
    s_waitcnt lgkmcnt(4)
    v_mfma_f32_16x16x32_bf16 v[80:83], v[156:159], v[128:131], v[80:83]
    v_cvt_pk_bf16_f32 v25, v26, v27
    v_cvt_pk_bf16_f32 v26, v28, v29
    v_mfma_f32_16x16x32_bf16 v[84:87], v[156:159], v[132:135], v[84:87]
    v_cvt_pk_bf16_f32 v27, v30, v31
    s_add_u32 s41, s41, s59
    v_mfma_f32_16x16x32_bf16 v[88:91], v[156:159], v[136:139], v[88:91]
    v_permlane16_swap_b32 v8, v10
    v_permlane16_swap_b32 v9, v11
    v_mfma_f32_16x16x32_bf16 v[92:95], v[156:159], v[140:143], v[92:95]
    v_permlane16_swap_b32 v24, v26
    v_permlane16_swap_b32 v25, v27
    s_waitcnt lgkmcnt(3)
    v_mfma_f32_16x16x32_bf16 v[64:67], v[192:195], v[176:179], v[64:67]
    ds_read_b128 v[144:147], v224 offset:4096
    buffer_store_dwordx4 v[8:11], v230, s[64:67], s41 offen offset:0 sc1
    v_mfma_f32_16x16x32_bf16 v[68:71], v[192:195], v[180:183], v[68:71]
    ds_read_b128 v[148:151], v224 offset:6144
    buffer_store_dwordx4 v[24:27], v230, s[64:67], s41 offen offset:1024 sc1
    v_mfma_f32_16x16x32_bf16 v[72:75], v[192:195], v[184:187], v[72:75]
    ds_read_b128 v[152:155], v225 offset:4096
    ds_read_b128 v[156:159], v225 offset:6144
    v_mfma_f32_16x16x32_bf16 v[76:79], v[192:195], v[188:191], v[76:79]
    s_waitcnt lgkmcnt(6)
    v_mfma_f32_16x16x32_bf16 v[80:83], v[196:199], v[176:179], v[80:83]
    v_mfma_f32_16x16x32_bf16 v[84:87], v[196:199], v[180:183], v[84:87]
    v_mfma_f32_16x16x32_bf16 v[88:91], v[196:199], v[184:187], v[88:91]
    v_mfma_f32_16x16x32_bf16 v[92:95], v[196:199], v[188:191], v[92:95]
    s_waitcnt lgkmcnt(5)
    v_mfma_f32_16x16x32_bf16 v[64:67], v[200:203], v[208:211], v[64:67]
    v_mfma_f32_16x16x32_bf16 v[68:71], v[200:203], v[212:215], v[68:71]
    v_mfma_f32_16x16x32_bf16 v[72:75], v[200:203], v[216:219], v[72:75]
    v_mfma_f32_16x16x32_bf16 v[76:79], v[200:203], v[220:223], v[76:79]
    s_waitcnt lgkmcnt(4)
    v_mfma_f32_16x16x32_bf16 v[80:83], v[204:207], v[208:211], v[80:83]
    v_mfma_f32_16x16x32_bf16 v[84:87], v[204:207], v[212:215], v[84:87]
    v_mfma_f32_16x16x32_bf16 v[88:91], v[204:207], v[216:219], v[88:91]
    v_mfma_f32_16x16x32_bf16 v[92:95], v[204:207], v[220:223], v[92:95]
    s_barrier
    s_waitcnt lgkmcnt(3)
    v_mfma_f32_16x16x32_bf16 v[32:35], v[144:147], v[160:163], v[32:35]
    ds_read_b128 v[192:195], v248 offset:4096
    v_cvt_pk_bf16_f32 v64, v64, v65
    v_mfma_f32_16x16x32_bf16 v[36:39], v[144:147], v[164:167], v[36:39]
    ds_read_b128 v[196:199], v248 offset:6144
    v_cvt_pk_bf16_f32 v65, v66, v67
    v_mfma_f32_16x16x32_bf16 v[40:43], v[144:147], v[168:171], v[40:43]
    ds_read_b128 v[200:203], v249 offset:4096
    v_cvt_pk_bf16_f32 v66, v68, v69
    v_mfma_f32_16x16x32_bf16 v[44:47], v[144:147], v[172:175], v[44:47]
    ds_read_b128 v[204:207], v249 offset:6144
    v_cvt_pk_bf16_f32 v67, v70, v71
    s_waitcnt lgkmcnt(6)
    v_mfma_f32_16x16x32_bf16 v[48:51], v[148:151], v[160:163], v[48:51]
    v_cvt_pk_bf16_f32 v80, v80, v81
    v_cvt_pk_bf16_f32 v81, v82, v83
    v_mfma_f32_16x16x32_bf16 v[52:55], v[148:151], v[164:167], v[52:55]
    v_cvt_pk_bf16_f32 v82, v84, v85
    v_cvt_pk_bf16_f32 v83, v86, v87
    v_mfma_f32_16x16x32_bf16 v[56:59], v[148:151], v[168:171], v[56:59]
    s_mul_i32 s41, s60, 2
    s_add_u32 s41, s41, s58
    v_mfma_f32_16x16x32_bf16 v[60:63], v[148:151], v[172:175], v[60:63]
    v_permlane16_swap_b32 v64, v66
    v_permlane16_swap_b32 v65, v67
    s_waitcnt lgkmcnt(5)
    v_mfma_f32_16x16x32_bf16 v[32:35], v[152:155], v[128:131], v[32:35]
    v_permlane16_swap_b32 v80, v82
    v_permlane16_swap_b32 v81, v83
    v_mfma_f32_16x16x32_bf16 v[36:39], v[152:155], v[132:135], v[36:39]
    buffer_store_dwordx4 v[64:67], v230, s[64:67], s41 offen offset:0 sc1
    buffer_store_dwordx4 v[80:83], v230, s[64:67], s41 offen offset:1024 sc1
    v_mfma_f32_16x16x32_bf16 v[40:43], v[152:155], v[136:139], v[40:43]
    v_cvt_pk_bf16_f32 v72, v72, v73
    v_cvt_pk_bf16_f32 v73, v74, v75
    v_mfma_f32_16x16x32_bf16 v[44:47], v[152:155], v[140:143], v[44:47]
    v_cvt_pk_bf16_f32 v74, v76, v77
    v_cvt_pk_bf16_f32 v75, v78, v79
    s_waitcnt lgkmcnt(4)
    v_mfma_f32_16x16x32_bf16 v[48:51], v[156:159], v[128:131], v[48:51]
    v_cvt_pk_bf16_f32 v88, v88, v89
    v_cvt_pk_bf16_f32 v89, v90, v91
    v_mfma_f32_16x16x32_bf16 v[52:55], v[156:159], v[132:135], v[52:55]
    v_cvt_pk_bf16_f32 v90, v92, v93
    v_cvt_pk_bf16_f32 v91, v94, v95
    v_mfma_f32_16x16x32_bf16 v[56:59], v[156:159], v[136:139], v[56:59]
    s_add_u32 s41, s41, s59
    v_permlane16_swap_b32 v72, v74
    v_mfma_f32_16x16x32_bf16 v[60:63], v[156:159], v[140:143], v[60:63]
    v_permlane16_swap_b32 v73, v75
    v_permlane16_swap_b32 v88, v90
    s_waitcnt lgkmcnt(3)
    v_mfma_f32_16x16x32_bf16 v[32:35], v[192:195], v[176:179], v[32:35]
    ds_read_b128 v[144:147], v224 offset:12288
    v_permlane16_swap_b32 v89, v91
    v_mfma_f32_16x16x32_bf16 v[36:39], v[192:195], v[180:183], v[36:39]
    ds_read_b128 v[148:151], v224 offset:14336
    buffer_store_dwordx4 v[72:75], v230, s[64:67], s41 offen offset:0 sc1
    v_mfma_f32_16x16x32_bf16 v[40:43], v[192:195], v[184:187], v[40:43]
    ds_read_b128 v[152:155], v225 offset:12288
    buffer_store_dwordx4 v[88:91], v230, s[64:67], s41 offen offset:1024 sc1
    v_mfma_f32_16x16x32_bf16 v[44:47], v[192:195], v[188:191], v[44:47]
    ds_read_b128 v[156:159], v225 offset:14336
    s_waitcnt lgkmcnt(6)
    v_mfma_f32_16x16x32_bf16 v[48:51], v[196:199], v[176:179], v[48:51]
    v_mfma_f32_16x16x32_bf16 v[52:55], v[196:199], v[180:183], v[52:55]
    v_mfma_f32_16x16x32_bf16 v[56:59], v[196:199], v[184:187], v[56:59]
    v_mfma_f32_16x16x32_bf16 v[60:63], v[196:199], v[188:191], v[60:63]
    s_waitcnt lgkmcnt(5)
    v_mfma_f32_16x16x32_bf16 v[32:35], v[200:203], v[208:211], v[32:35]
    v_mfma_f32_16x16x32_bf16 v[36:39], v[200:203], v[212:215], v[36:39]
    v_mfma_f32_16x16x32_bf16 v[40:43], v[200:203], v[216:219], v[40:43]
    v_mfma_f32_16x16x32_bf16 v[44:47], v[200:203], v[220:223], v[44:47]
    s_waitcnt lgkmcnt(4)
    v_mfma_f32_16x16x32_bf16 v[48:51], v[204:207], v[208:211], v[48:51]
    v_mfma_f32_16x16x32_bf16 v[52:55], v[204:207], v[212:215], v[52:55]
    v_mfma_f32_16x16x32_bf16 v[56:59], v[204:207], v[216:219], v[56:59]
    v_mfma_f32_16x16x32_bf16 v[60:63], v[204:207], v[220:223], v[60:63]
    s_waitcnt lgkmcnt(3)
    v_mfma_f32_16x16x32_bf16 v[96:99], v[144:147], v[160:163], v[96:99]
    ds_read_b128 v[192:195], v248 offset:12288
    v_cvt_pk_bf16_f32 v32, v32, v33
    v_mfma_f32_16x16x32_bf16 v[100:103], v[144:147], v[164:167], v[100:103]
    ds_read_b128 v[196:199], v248 offset:14336
    v_cvt_pk_bf16_f32 v33, v34, v35
    v_mfma_f32_16x16x32_bf16 v[104:107], v[144:147], v[168:171], v[104:107]
    ds_read_b128 v[200:203], v249 offset:12288
    v_cvt_pk_bf16_f32 v34, v36, v37
    v_mfma_f32_16x16x32_bf16 v[108:111], v[144:147], v[172:175], v[108:111]
    ds_read_b128 v[204:207], v249 offset:14336
    v_cvt_pk_bf16_f32 v35, v38, v39
    s_waitcnt lgkmcnt(6)
    v_mfma_f32_16x16x32_bf16 v[112:115], v[148:151], v[160:163], v[112:115]
    v_cvt_pk_bf16_f32 v48, v48, v49
    v_cvt_pk_bf16_f32 v49, v50, v51
    v_mfma_f32_16x16x32_bf16 v[116:119], v[148:151], v[164:167], v[116:119]
    v_cvt_pk_bf16_f32 v50, v52, v53
    v_cvt_pk_bf16_f32 v51, v54, v55
    v_mfma_f32_16x16x32_bf16 v[120:123], v[148:151], v[168:171], v[120:123]
    s_mul_i32 s41, s60, 1
    s_add_u32 s41, s41, s58
    v_mfma_f32_16x16x32_bf16 v[124:127], v[148:151], v[172:175], v[124:127]
    v_permlane16_swap_b32 v32, v34
    v_permlane16_swap_b32 v33, v35
    s_waitcnt lgkmcnt(5)
    v_mfma_f32_16x16x32_bf16 v[96:99], v[152:155], v[128:131], v[96:99]
    v_permlane16_swap_b32 v48, v50
    v_permlane16_swap_b32 v49, v51
    v_mfma_f32_16x16x32_bf16 v[100:103], v[152:155], v[132:135], v[100:103]
    buffer_store_dwordx4 v[32:35], v230, s[64:67], s41 offen offset:0 sc1
    buffer_store_dwordx4 v[48:51], v230, s[64:67], s41 offen offset:1024 sc1
    v_mfma_f32_16x16x32_bf16 v[104:107], v[152:155], v[136:139], v[104:107]
    v_cvt_pk_bf16_f32 v40, v40, v41
    v_cvt_pk_bf16_f32 v41, v42, v43
    v_mfma_f32_16x16x32_bf16 v[108:111], v[152:155], v[140:143], v[108:111]
    v_cvt_pk_bf16_f32 v42, v44, v45
    v_cvt_pk_bf16_f32 v43, v46, v47
    s_waitcnt lgkmcnt(4)
    v_mfma_f32_16x16x32_bf16 v[112:115], v[156:159], v[128:131], v[112:115]
    v_cvt_pk_bf16_f32 v56, v56, v57
    v_cvt_pk_bf16_f32 v57, v58, v59
    v_mfma_f32_16x16x32_bf16 v[116:119], v[156:159], v[132:135], v[116:119]
    v_cvt_pk_bf16_f32 v58, v60, v61
    v_cvt_pk_bf16_f32 v59, v62, v63
    v_mfma_f32_16x16x32_bf16 v[120:123], v[156:159], v[136:139], v[120:123]
    s_add_u32 s41, s41, s59
    v_permlane16_swap_b32 v40, v42
    v_mfma_f32_16x16x32_bf16 v[124:127], v[156:159], v[140:143], v[124:127]
    v_permlane16_swap_b32 v41, v43
    v_permlane16_swap_b32 v56, v58
    s_waitcnt lgkmcnt(3)
    v_mfma_f32_16x16x32_bf16 v[96:99], v[192:195], v[176:179], v[96:99]
    v_permlane16_swap_b32 v57, v59
    buffer_store_dwordx4 v[40:43], v230, s[64:67], s41 offen offset:0 sc1
    v_mfma_f32_16x16x32_bf16 v[100:103], v[192:195], v[180:183], v[100:103]
    buffer_store_dwordx4 v[56:59], v230, s[64:67], s41 offen offset:1024 sc1
    v_mfma_f32_16x16x32_bf16 v[104:107], v[192:195], v[184:187], v[104:107]
    v_mfma_f32_16x16x32_bf16 v[108:111], v[192:195], v[188:191], v[108:111]
    s_waitcnt lgkmcnt(2)
    v_mfma_f32_16x16x32_bf16 v[112:115], v[196:199], v[176:179], v[112:115]
    v_mfma_f32_16x16x32_bf16 v[116:119], v[196:199], v[180:183], v[116:119]
    v_mfma_f32_16x16x32_bf16 v[120:123], v[196:199], v[184:187], v[120:123]
    v_mfma_f32_16x16x32_bf16 v[124:127], v[196:199], v[188:191], v[124:127]
    s_waitcnt lgkmcnt(1)
    v_mfma_f32_16x16x32_bf16 v[96:99], v[200:203], v[208:211], v[96:99]
    v_mfma_f32_16x16x32_bf16 v[100:103], v[200:203], v[212:215], v[100:103]
    v_mfma_f32_16x16x32_bf16 v[104:107], v[200:203], v[216:219], v[104:107]
    v_mfma_f32_16x16x32_bf16 v[108:111], v[200:203], v[220:223], v[108:111]
    s_waitcnt lgkmcnt(0)
    v_mfma_f32_16x16x32_bf16 v[112:115], v[204:207], v[208:211], v[112:115]
    v_mfma_f32_16x16x32_bf16 v[116:119], v[204:207], v[212:215], v[116:119]
    v_mfma_f32_16x16x32_bf16 v[120:123], v[204:207], v[216:219], v[120:123]
    v_mfma_f32_16x16x32_bf16 v[124:127], v[204:207], v[220:223], v[124:127]
    s_nop 0
    v_cvt_pk_bf16_f32 v96, v96, v97
    v_cvt_pk_bf16_f32 v97, v98, v99
    v_cvt_pk_bf16_f32 v98, v100, v101
    v_cvt_pk_bf16_f32 v99, v102, v103
    s_nop 0
    v_cvt_pk_bf16_f32 v112, v112, v113
    v_cvt_pk_bf16_f32 v113, v114, v115
    v_cvt_pk_bf16_f32 v114, v116, v117
    v_cvt_pk_bf16_f32 v115, v118, v119
    s_mul_i32 s41, s60, 3
    s_add_u32 s41, s41, s58
    v_permlane16_swap_b32 v96, v98
    v_permlane16_swap_b32 v97, v99
    v_permlane16_swap_b32 v112, v114
    v_permlane16_swap_b32 v113, v115
    buffer_store_dwordx4 v[96:99], v230, s[64:67], s41 offen offset:0 sc1
    s_nop 0
    buffer_store_dwordx4 v[112:115], v230, s[64:67], s41 offen offset:1024 sc1
    v_cvt_pk_bf16_f32 v104, v104, v105
    v_cvt_pk_bf16_f32 v105, v106, v107
    v_cvt_pk_bf16_f32 v106, v108, v109
    v_cvt_pk_bf16_f32 v107, v110, v111
    v_cvt_pk_bf16_f32 v120, v120, v121
    v_cvt_pk_bf16_f32 v121, v122, v123
    v_cvt_pk_bf16_f32 v122, v124, v125
    v_cvt_pk_bf16_f32 v123, v126, v127
    s_add_u32 s41, s41, s59
    v_permlane16_swap_b32 v104, v106
    v_permlane16_swap_b32 v105, v107
    v_permlane16_swap_b32 v120, v122
    v_permlane16_swap_b32 v121, v123
    buffer_store_dwordx4 v[104:107], v230, s[64:67], s41 offen offset:0 sc1
    s_nop 0
    buffer_store_dwordx4 v[120:123], v230, s[64:67], s41 offen offset:1024 sc1
    s_branch p1_cdone
p1_end_v:
p1_btype:
    s_bitcmp1_b32 s37, 0
    s_cbranch_scc1 p1_bvtype
    s_cmp_lg_u32 s39, 0
    s_cbranch_scc1 p1_nopf_7
    s_getpc_b64 s[72:73]
pc_8:
    s_add_u32 s72, s72, p1_loop_bk-pc_8
    s_addc_u32 s73, s73, 0
    v_lshlrev_b32 v248, 3, v230
    v_min_u32 v248, p1_end_bk-p1_loop_bk-4, v248
    v_and_b32 v248, -4, v248
    v_add_co_u32 v248, vcc, s72, v248
    v_mov_b32 v249, s73
    v_addc_co_u32 v249, vcc, 0, v249, vcc
    global_load_dword v250, v[248:249], off
p1_nopf_7:
    v_lshrrev_b32 v232, 8, v230
    v_lshrrev_b32 v233, 6, v230
    v_and_b32 v233, 3, v233
    v_lshlrev_b32 v234, 3, v232
    v_add_u32 v234, v234, v233
    v_lshlrev_b32 v234, 6, v234
    s_lshr_b32 s41, s39, 1
    v_and_b32 v232, 1, v232
    v_xor_b32 v232, s41, v232
    v_lshlrev_b32 v232, 5, v232
    v_add_u32 v234, v234, v232
    v_lshrrev_b32 v235, 4, v230
    v_and_b32 v235, 3, v235
    v_and_b32 v236, 1, v235
    v_lshlrev_b32 v236, 1, v236
    v_lshrrev_b32 v235, 1, v235
    v_or_b32 v235, v235, v236
    v_lshlrev_b32 v235, 3, v235
    v_add_u32 v234, v234, v235
    v_add_u32 v231, 49152, v234
    v_mov_b32 v240, 0
    v_mov_b32 v241, 0
    v_mov_b32 v242, 0
    v_mov_b32 v243, 0
    v_mov_b32 v244, 0
    v_mov_b32 v245, 0
    v_mov_b32 v246, 0
    v_mov_b32 v247, 0
    s_mov_b32 s58, 0
    s_cmp_eq_u32 s38, 1
    s_cselect_b32 s58, 4194304, s58
    s_cmp_eq_u32 s38, 2
    s_cselect_b32 s58, 4196352, s58
    s_cmp_eq_u32 s38, 3
    s_cselect_b32 s58, 12582912, s58
    s_add_u32 s41, s38, 1
    s_and_b32 s41, s41, 2
    s_cmp_eq_u32 s41, 0
    s_mov_b32 s44, 262144
    s_cselect_b32 s59, 131072, s44
    s_mov_b32 s44, 4096
    s_cselect_b32 s60, 2048, s44
    s_mov_b32 s44, 1.0
    s_cselect_b32 s42, 0x3e8293ee, s44
    s_mov_b32 s43, s42
    s_lshl_b32 s41, s37, 2
    s_and_b32 s44, s39, 2
    s_add_u32 s41, s41, s44
    s_mul_i32 s41, s41, s59
    s_add_u32 s58, s58, s41
    s_lshl_b32 s41, s36, 3
    s_and_b32 s44, s39, 1
    s_lshl_b32 s44, s44, 2
    s_add_u32 s41, s41, s44
    s_mul_i32 s41, s41, s60
    s_add_u32 s58, s58, s41
    s_lshr_b32 s71, s37, 1
    s_lshl_b32 s41, s36, 1
    s_and_b32 s44, s39, 1
    s_add_u32 s41, s41, s44
    s_lshl_b32 s41, s41, 2
    s_xor_b32 s44, s71, 3
    s_add_u32 s41, s41, s44
    s_lshl_b32 s41, s41, 12
    s_lshr_b32 s44, s39, 1
    s_lshl_b32 s44, s44, 10
    s_add_u32 s41, s41, s44
    s_add_u32 s63, s41, 16777216
    s_mov_b32 s48, 13
    s_barrier
    ds_read_b64_tr_b16 v[160:161], v226 offset:0
    ds_read_b64_tr_b16 v[162:163], v226 offset:1024
    ds_read_b128 v[128:131], v224 offset:0
    ds_read_b64_tr_b16 v[164:165], v227 offset:0
    ds_read_b64_tr_b16 v[166:167], v227 offset:1024
    ds_read_b128 v[132:135], v224 offset:2048
    ds_read_b64_tr_b16 v[168:169], v228 offset:0
    ds_read_b64_tr_b16 v[170:171], v228 offset:1024
    ds_read_b64_tr_b16 v[172:173], v229 offset:0
    ds_read_b64_tr_b16 v[174:175], v229 offset:1024
    ds_read_b128 v[136:139], v224 offset:4096
    ds_read_b128 v[140:143], v224 offset:6144
    ds_read_b128 v[144:147], v224 offset:8192
    ds_read_b128 v[148:151], v224 offset:10240
    ds_read_b128 v[152:155], v224 offset:12288
    ds_read_b128 v[156:159], v224 offset:14336
    ds_read_b64_tr_b16 v[232:233], v231 offset:0
    ds_read_b64_tr_b16 v[234:235], v231 offset:256
p1_loop_bk:
    s_waitcnt lgkmcnt(0)
    v_mfma_f32_16x16x32_bf16 v[0:3], v[160:163], v[128:131], v[0:3]
    ds_read_b64_tr_b16 v[208:209], v226 offset:8192
    v_mfma_f32_16x16x32_bf16 v[8:11], v[164:167], v[128:131], v[8:11]
    ds_read_b64_tr_b16 v[210:211], v226 offset:9216
    v_mfma_f32_16x16x32_bf16 v[16:19], v[168:171], v[128:131], v[16:19]
    ds_read_b128 v[176:179], v225 offset:0
    v_mfma_f32_16x16x32_bf16 v[24:27], v[172:175], v[128:131], v[24:27]
    ds_read_b64_tr_b16 v[212:213], v227 offset:8192
    v_mfma_f32_16x16x32_bf16 v[4:7], v[160:163], v[132:135], v[4:7]
    ds_read_b64_tr_b16 v[214:215], v227 offset:9216
    v_mfma_f32_16x16x32_bf16 v[12:15], v[164:167], v[132:135], v[12:15]
    ds_read_b128 v[180:183], v225 offset:2048
    v_mfma_f32_16x16x32_bf16 v[20:23], v[168:171], v[132:135], v[20:23]
    ds_read_b64_tr_b16 v[216:217], v228 offset:8192
    v_mfma_f32_16x16x32_bf16 v[28:31], v[172:175], v[132:135], v[28:31]
    ds_read_b64_tr_b16 v[218:219], v228 offset:9216
    v_mfma_f32_16x16x32_bf16 v[32:35], v[160:163], v[136:139], v[32:35]
    ds_read_b64_tr_b16 v[220:221], v229 offset:8192
    v_mfma_f32_16x16x32_bf16 v[40:43], v[164:167], v[136:139], v[40:43]
    ds_read_b64_tr_b16 v[222:223], v229 offset:9216
    v_mfma_f32_16x16x32_bf16 v[48:51], v[168:171], v[136:139], v[48:51]
    ds_read_b128 v[184:187], v225 offset:4096
    v_mfma_f32_16x16x32_bf16 v[56:59], v[172:175], v[136:139], v[56:59]
    ds_read_b128 v[188:191], v225 offset:6144
    v_mfma_f32_16x16x32_bf16 v[36:39], v[160:163], v[140:143], v[36:39]
    ds_read_b128 v[192:195], v225 offset:8192
    v_mfma_f32_16x16x32_bf16 v[44:47], v[164:167], v[140:143], v[44:47]
    ds_read_b128 v[196:199], v225 offset:10240
    v_mfma_f32_16x16x32_bf16 v[52:55], v[168:171], v[140:143], v[52:55]
    ds_read_b128 v[200:203], v225 offset:12288
    v_mfma_f32_16x16x32_bf16 v[60:63], v[172:175], v[140:143], v[60:63]
    ds_read_b128 v[204:207], v225 offset:14336
    v_mfma_f32_16x16x32_bf16 v[64:67], v[160:163], v[144:147], v[64:67]
    ds_read_b64_tr_b16 v[236:237], v231 offset:2048
    v_mfma_f32_16x16x32_bf16 v[72:75], v[164:167], v[144:147], v[72:75]
    ds_read_b64_tr_b16 v[238:239], v231 offset:2304
    v_mfma_f32_16x16x32_bf16 v[80:83], v[168:171], v[144:147], v[80:83]
    v_mfma_f32_16x16x32_bf16 v[88:91], v[172:175], v[144:147], v[88:91]
    v_mfma_f32_16x16x32_bf16 v[68:71], v[160:163], v[148:151], v[68:71]
    v_mfma_f32_16x16x32_bf16 v[76:79], v[164:167], v[148:151], v[76:79]
    v_mfma_f32_16x16x32_bf16 v[84:87], v[168:171], v[148:151], v[84:87]
    v_mfma_f32_16x16x32_bf16 v[92:95], v[172:175], v[148:151], v[92:95]
    v_mfma_f32_16x16x32_bf16 v[96:99], v[160:163], v[152:155], v[96:99]
    v_mfma_f32_16x16x32_bf16 v[104:107], v[164:167], v[152:155], v[104:107]
    v_mfma_f32_16x16x32_bf16 v[112:115], v[168:171], v[152:155], v[112:115]
    v_mfma_f32_16x16x32_bf16 v[120:123], v[172:175], v[152:155], v[120:123]
    v_mfma_f32_16x16x32_bf16 v[100:103], v[160:163], v[156:159], v[100:103]
    v_mfma_f32_16x16x32_bf16 v[108:111], v[164:167], v[156:159], v[108:111]
    v_mfma_f32_16x16x32_bf16 v[116:119], v[168:171], v[156:159], v[116:119]
    v_mfma_f32_16x16x32_bf16 v[124:127], v[172:175], v[156:159], v[124:127]
    v_mfma_f32_16x16x32_bf16 v[240:243], v[232:235], v[152:155], v[240:243]
    v_mfma_f32_16x16x32_bf16 v[244:247], v[232:235], v[156:159], v[244:247]
    s_waitcnt lgkmcnt(0)
    v_mfma_f32_16x16x32_bf16 v[0:3], v[208:211], v[176:179], v[0:3]
    v_mfma_f32_16x16x32_bf16 v[8:11], v[212:215], v[176:179], v[8:11]
    v_mfma_f32_16x16x32_bf16 v[16:19], v[216:219], v[176:179], v[16:19]
    v_mfma_f32_16x16x32_bf16 v[24:27], v[220:223], v[176:179], v[24:27]
    v_mfma_f32_16x16x32_bf16 v[4:7], v[208:211], v[180:183], v[4:7]
    v_mfma_f32_16x16x32_bf16 v[12:15], v[212:215], v[180:183], v[12:15]
    v_mfma_f32_16x16x32_bf16 v[20:23], v[216:219], v[180:183], v[20:23]
    v_mfma_f32_16x16x32_bf16 v[28:31], v[220:223], v[180:183], v[28:31]
    s_add_u32 s46, s46, 53248
    s_mov_b32 s47, 53248
    s_cmp_eq_u32 s46, 159744
    s_cselect_b32 s47, 4294860800, s47
    s_cselect_b32 s46, 0, s46
    v_add_u32 v224, s47, v224
    v_add_u32 v225, s47, v225
    v_add_u32 v226, s47, v226
    v_add_u32 v227, s47, v227
    v_add_u32 v228, s47, v228
    v_add_u32 v229, s47, v229
    v_add_u32 v231, s47, v231
    s_barrier
    v_mfma_f32_16x16x32_bf16 v[32:35], v[208:211], v[184:187], v[32:35]
    ds_read_b64_tr_b16 v[160:161], v226 offset:0
    v_mfma_f32_16x16x32_bf16 v[40:43], v[212:215], v[184:187], v[40:43]
    ds_read_b64_tr_b16 v[162:163], v226 offset:1024
    v_mfma_f32_16x16x32_bf16 v[48:51], v[216:219], v[184:187], v[48:51]
    ds_read_b128 v[128:131], v224 offset:0
    v_mfma_f32_16x16x32_bf16 v[56:59], v[220:223], v[184:187], v[56:59]
    ds_read_b64_tr_b16 v[164:165], v227 offset:0
    v_mfma_f32_16x16x32_bf16 v[36:39], v[208:211], v[188:191], v[36:39]
    ds_read_b64_tr_b16 v[166:167], v227 offset:1024
    v_mfma_f32_16x16x32_bf16 v[44:47], v[212:215], v[188:191], v[44:47]
    ds_read_b128 v[132:135], v224 offset:2048
    v_mfma_f32_16x16x32_bf16 v[52:55], v[216:219], v[188:191], v[52:55]
    ds_read_b64_tr_b16 v[168:169], v228 offset:0
    v_mfma_f32_16x16x32_bf16 v[60:63], v[220:223], v[188:191], v[60:63]
    ds_read_b64_tr_b16 v[170:171], v228 offset:1024
    v_mfma_f32_16x16x32_bf16 v[64:67], v[208:211], v[192:195], v[64:67]
    ds_read_b64_tr_b16 v[172:173], v229 offset:0
    v_mfma_f32_16x16x32_bf16 v[72:75], v[212:215], v[192:195], v[72:75]
    ds_read_b64_tr_b16 v[174:175], v229 offset:1024
    v_mfma_f32_16x16x32_bf16 v[80:83], v[216:219], v[192:195], v[80:83]
    ds_read_b128 v[136:139], v224 offset:4096
    v_mfma_f32_16x16x32_bf16 v[88:91], v[220:223], v[192:195], v[88:91]
    ds_read_b128 v[140:143], v224 offset:6144
    v_mfma_f32_16x16x32_bf16 v[68:71], v[208:211], v[196:199], v[68:71]
    ds_read_b128 v[144:147], v224 offset:8192
    v_mfma_f32_16x16x32_bf16 v[76:79], v[212:215], v[196:199], v[76:79]
    ds_read_b128 v[148:151], v224 offset:10240
    v_mfma_f32_16x16x32_bf16 v[84:87], v[216:219], v[196:199], v[84:87]
    ds_read_b128 v[152:155], v224 offset:12288
    v_mfma_f32_16x16x32_bf16 v[92:95], v[220:223], v[196:199], v[92:95]
    ds_read_b128 v[156:159], v224 offset:14336
    v_mfma_f32_16x16x32_bf16 v[96:99], v[208:211], v[200:203], v[96:99]
    ds_read_b64_tr_b16 v[232:233], v231 offset:0
    v_mfma_f32_16x16x32_bf16 v[104:107], v[212:215], v[200:203], v[104:107]
    ds_read_b64_tr_b16 v[234:235], v231 offset:256
    v_mfma_f32_16x16x32_bf16 v[112:115], v[216:219], v[200:203], v[112:115]
    v_mfma_f32_16x16x32_bf16 v[120:123], v[220:223], v[200:203], v[120:123]
    v_mfma_f32_16x16x32_bf16 v[100:103], v[208:211], v[204:207], v[100:103]
    v_mfma_f32_16x16x32_bf16 v[108:111], v[212:215], v[204:207], v[108:111]
    v_mfma_f32_16x16x32_bf16 v[116:119], v[216:219], v[204:207], v[116:119]
    v_mfma_f32_16x16x32_bf16 v[124:127], v[220:223], v[204:207], v[124:127]
    v_mfma_f32_16x16x32_bf16 v[240:243], v[236:239], v[200:203], v[240:243]
    v_mfma_f32_16x16x32_bf16 v[244:247], v[236:239], v[204:207], v[244:247]
    s_sub_u32 s48, s48, 1
    s_cmp_lg_u32 s48, 0
    s_cbranch_scc1 p1_loop_bk
    s_waitcnt lgkmcnt(0) vmcnt(0)
    v_mfma_f32_16x16x32_bf16 v[0:3], v[160:163], v[128:131], v[0:3]
    ds_read_b64_tr_b16 v[208:209], v226 offset:8192
    v_mfma_f32_16x16x32_bf16 v[8:11], v[164:167], v[128:131], v[8:11]
    ds_read_b64_tr_b16 v[210:211], v226 offset:9216
    v_mfma_f32_16x16x32_bf16 v[16:19], v[168:171], v[128:131], v[16:19]
    ds_read_b128 v[176:179], v225 offset:0
    v_mfma_f32_16x16x32_bf16 v[24:27], v[172:175], v[128:131], v[24:27]
    ds_read_b64_tr_b16 v[212:213], v227 offset:8192
    v_mfma_f32_16x16x32_bf16 v[4:7], v[160:163], v[132:135], v[4:7]
    ds_read_b64_tr_b16 v[214:215], v227 offset:9216
    v_mfma_f32_16x16x32_bf16 v[12:15], v[164:167], v[132:135], v[12:15]
    ds_read_b128 v[180:183], v225 offset:2048
    v_mfma_f32_16x16x32_bf16 v[20:23], v[168:171], v[132:135], v[20:23]
    ds_read_b64_tr_b16 v[216:217], v228 offset:8192
    v_mfma_f32_16x16x32_bf16 v[28:31], v[172:175], v[132:135], v[28:31]
    ds_read_b64_tr_b16 v[218:219], v228 offset:9216
    v_mfma_f32_16x16x32_bf16 v[32:35], v[160:163], v[136:139], v[32:35]
    ds_read_b64_tr_b16 v[220:221], v229 offset:8192
    v_mfma_f32_16x16x32_bf16 v[40:43], v[164:167], v[136:139], v[40:43]
    ds_read_b64_tr_b16 v[222:223], v229 offset:9216
    v_mfma_f32_16x16x32_bf16 v[48:51], v[168:171], v[136:139], v[48:51]
    ds_read_b128 v[184:187], v225 offset:4096
    v_mfma_f32_16x16x32_bf16 v[56:59], v[172:175], v[136:139], v[56:59]
    ds_read_b128 v[188:191], v225 offset:6144
    v_mfma_f32_16x16x32_bf16 v[36:39], v[160:163], v[140:143], v[36:39]
    ds_read_b128 v[192:195], v225 offset:8192
    v_mfma_f32_16x16x32_bf16 v[44:47], v[164:167], v[140:143], v[44:47]
    ds_read_b128 v[196:199], v225 offset:10240
    v_mfma_f32_16x16x32_bf16 v[52:55], v[168:171], v[140:143], v[52:55]
    ds_read_b128 v[200:203], v225 offset:12288
    v_mfma_f32_16x16x32_bf16 v[60:63], v[172:175], v[140:143], v[60:63]
    ds_read_b128 v[204:207], v225 offset:14336
    v_mfma_f32_16x16x32_bf16 v[64:67], v[160:163], v[144:147], v[64:67]
    ds_read_b64_tr_b16 v[236:237], v231 offset:2048
    v_mfma_f32_16x16x32_bf16 v[72:75], v[164:167], v[144:147], v[72:75]
    ds_read_b64_tr_b16 v[238:239], v231 offset:2304
    v_mfma_f32_16x16x32_bf16 v[80:83], v[168:171], v[144:147], v[80:83]
    v_mfma_f32_16x16x32_bf16 v[88:91], v[172:175], v[144:147], v[88:91]
    v_mfma_f32_16x16x32_bf16 v[68:71], v[160:163], v[148:151], v[68:71]
    v_mfma_f32_16x16x32_bf16 v[76:79], v[164:167], v[148:151], v[76:79]
    v_mfma_f32_16x16x32_bf16 v[84:87], v[168:171], v[148:151], v[84:87]
    v_mfma_f32_16x16x32_bf16 v[92:95], v[172:175], v[148:151], v[92:95]
    v_mfma_f32_16x16x32_bf16 v[96:99], v[160:163], v[152:155], v[96:99]
    v_mfma_f32_16x16x32_bf16 v[104:107], v[164:167], v[152:155], v[104:107]
    v_mfma_f32_16x16x32_bf16 v[112:115], v[168:171], v[152:155], v[112:115]
    v_mfma_f32_16x16x32_bf16 v[120:123], v[172:175], v[152:155], v[120:123]
    v_mfma_f32_16x16x32_bf16 v[100:103], v[160:163], v[156:159], v[100:103]
    v_mfma_f32_16x16x32_bf16 v[108:111], v[164:167], v[156:159], v[108:111]
    v_mfma_f32_16x16x32_bf16 v[116:119], v[168:171], v[156:159], v[116:119]
    v_mfma_f32_16x16x32_bf16 v[124:127], v[172:175], v[156:159], v[124:127]
    v_mfma_f32_16x16x32_bf16 v[240:243], v[232:235], v[152:155], v[240:243]
    v_mfma_f32_16x16x32_bf16 v[244:247], v[232:235], v[156:159], v[244:247]
    s_waitcnt lgkmcnt(0)
    v_mfma_f32_16x16x32_bf16 v[0:3], v[208:211], v[176:179], v[0:3]
    v_add_u32 v248, 4294914048, v224
    v_add_u32 v224, 53248, v224
    v_mfma_f32_16x16x32_bf16 v[8:11], v[212:215], v[176:179], v[8:11]
    v_add_u32 v249, 4294914048, v225
    v_add_u32 v225, 53248, v225
    v_mfma_f32_16x16x32_bf16 v[16:19], v[216:219], v[176:179], v[16:19]
    v_add_u32 v250, 4294914048, v226
    v_add_u32 v226, 53248, v226
    v_mfma_f32_16x16x32_bf16 v[24:27], v[220:223], v[176:179], v[24:27]
    v_add_u32 v251, 4294914048, v227
    v_add_u32 v227, 53248, v227
    v_mfma_f32_16x16x32_bf16 v[4:7], v[208:211], v[180:183], v[4:7]
    v_add_u32 v252, 4294914048, v228
    v_add_u32 v228, 53248, v228
    v_mfma_f32_16x16x32_bf16 v[12:15], v[212:215], v[180:183], v[12:15]
    v_add_u32 v253, 4294914048, v229
    v_add_u32 v229, 53248, v229
    v_mfma_f32_16x16x32_bf16 v[20:23], v[216:219], v[180:183], v[20:23]
    v_add_u32 v254, 4294914048, v231
    v_add_u32 v231, 53248, v231
    v_mfma_f32_16x16x32_bf16 v[28:31], v[220:223], v[180:183], v[28:31]
    s_barrier
    v_mfma_f32_16x16x32_bf16 v[32:35], v[208:211], v[184:187], v[32:35]
    ds_read_b64_tr_b16 v[160:161], v226 offset:0
    v_mfma_f32_16x16x32_bf16 v[40:43], v[212:215], v[184:187], v[40:43]
    ds_read_b64_tr_b16 v[162:163], v226 offset:1024
    v_mfma_f32_16x16x32_bf16 v[48:51], v[216:219], v[184:187], v[48:51]
    ds_read_b128 v[144:147], v224 offset:0
    v_mfma_f32_16x16x32_bf16 v[56:59], v[220:223], v[184:187], v[56:59]
    ds_read_b64_tr_b16 v[164:165], v227 offset:0
    v_mfma_f32_16x16x32_bf16 v[36:39], v[208:211], v[188:191], v[36:39]
    ds_read_b64_tr_b16 v[166:167], v227 offset:1024
    v_mfma_f32_16x16x32_bf16 v[44:47], v[212:215], v[188:191], v[44:47]
    ds_read_b128 v[148:151], v224 offset:2048
    v_mfma_f32_16x16x32_bf16 v[52:55], v[216:219], v[188:191], v[52:55]
    ds_read_b64_tr_b16 v[168:169], v228 offset:0
    v_mfma_f32_16x16x32_bf16 v[60:63], v[220:223], v[188:191], v[60:63]
    ds_read_b64_tr_b16 v[170:171], v228 offset:1024
    v_mfma_f32_16x16x32_bf16 v[64:67], v[208:211], v[192:195], v[64:67]
    ds_read_b64_tr_b16 v[172:173], v229 offset:0
    v_mfma_f32_16x16x32_bf16 v[72:75], v[212:215], v[192:195], v[72:75]
    ds_read_b64_tr_b16 v[174:175], v229 offset:1024
    v_mfma_f32_16x16x32_bf16 v[80:83], v[216:219], v[192:195], v[80:83]
    ds_read_b64_tr_b16 v[128:129], v226 offset:8192
    v_mfma_f32_16x16x32_bf16 v[88:91], v[220:223], v[192:195], v[88:91]
    ds_read_b64_tr_b16 v[130:131], v226 offset:9216
    v_mfma_f32_16x16x32_bf16 v[68:71], v[208:211], v[196:199], v[68:71]
    ds_read_b128 v[152:155], v225 offset:0
    v_mfma_f32_16x16x32_bf16 v[76:79], v[212:215], v[196:199], v[76:79]
    ds_read_b64_tr_b16 v[132:133], v227 offset:8192
    v_mfma_f32_16x16x32_bf16 v[84:87], v[216:219], v[196:199], v[84:87]
    ds_read_b64_tr_b16 v[134:135], v227 offset:9216
    v_mfma_f32_16x16x32_bf16 v[92:95], v[220:223], v[196:199], v[92:95]
    ds_read_b128 v[156:159], v225 offset:2048
    v_mfma_f32_16x16x32_bf16 v[96:99], v[208:211], v[200:203], v[96:99]
    ds_read_b64_tr_b16 v[136:137], v228 offset:8192
    v_mfma_f32_16x16x32_bf16 v[104:107], v[212:215], v[200:203], v[104:107]
    ds_read_b64_tr_b16 v[138:139], v228 offset:9216
    s_barrier
    v_mfma_f32_16x16x32_bf16 v[112:115], v[216:219], v[200:203], v[112:115]
    ds_read_b64_tr_b16 v[140:141], v229 offset:8192
    v_mfma_f32_16x16x32_bf16 v[120:123], v[220:223], v[200:203], v[120:123]
    ds_read_b64_tr_b16 v[142:143], v229 offset:9216
    v_mfma_f32_16x16x32_bf16 v[100:103], v[208:211], v[204:207], v[100:103]
    ds_read_b64_tr_b16 v[176:177], v250 offset:0
    v_mfma_f32_16x16x32_bf16 v[108:111], v[212:215], v[204:207], v[108:111]
    ds_read_b64_tr_b16 v[178:179], v250 offset:1024
    v_mfma_f32_16x16x32_bf16 v[116:119], v[216:219], v[204:207], v[116:119]
    ds_read_b64_tr_b16 v[180:181], v251 offset:0
    v_mfma_f32_16x16x32_bf16 v[124:127], v[220:223], v[204:207], v[124:127]
    ds_read_b64_tr_b16 v[182:183], v251 offset:1024
    v_mfma_f32_16x16x32_bf16 v[240:243], v[236:239], v[200:203], v[240:243]
    ds_read_b64_tr_b16 v[184:185], v252 offset:0
    v_mfma_f32_16x16x32_bf16 v[244:247], v[236:239], v[204:207], v[244:247]
    ds_read_b64_tr_b16 v[186:187], v252 offset:1024
    s_waitcnt lgkmcnt(15)
    v_mfma_f32_16x16x32_bf16 v[0:3], v[160:163], v[144:147], v[0:3]
    ds_read_b64_tr_b16 v[188:189], v253 offset:0
    ds_read_b64_tr_b16 v[190:191], v253 offset:1024
    v_mfma_f32_16x16x32_bf16 v[8:11], v[164:167], v[144:147], v[8:11]
    ds_read_b128 v[192:195], v248 offset:0
    ds_read_b128 v[196:199], v248 offset:2048
    v_mfma_f32_16x16x32_bf16 v[16:19], v[168:171], v[144:147], v[16:19]
    ds_read_b64_tr_b16 v[208:209], v250 offset:8192
    ds_read_b64_tr_b16 v[210:211], v250 offset:9216
    v_mfma_f32_16x16x32_bf16 v[24:27], v[172:175], v[144:147], v[24:27]
    ds_read_b64_tr_b16 v[212:213], v251 offset:8192
    ds_read_b64_tr_b16 v[214:215], v251 offset:9216
    v_mfma_f32_16x16x32_bf16 v[4:7], v[160:163], v[148:151], v[4:7]
    ds_read_b64_tr_b16 v[216:217], v252 offset:8192
    ds_read_b64_tr_b16 v[218:219], v252 offset:9216
    v_mfma_f32_16x16x32_bf16 v[12:15], v[164:167], v[148:151], v[12:15]
    ds_read_b64_tr_b16 v[220:221], v253 offset:8192
    ds_read_b64_tr_b16 v[222:223], v253 offset:9216
    v_mfma_f32_16x16x32_bf16 v[20:23], v[168:171], v[148:151], v[20:23]
    ds_read_b128 v[200:203], v249 offset:0
    ds_read_b128 v[204:207], v249 offset:2048
    v_mfma_f32_16x16x32_bf16 v[28:31], v[172:175], v[148:151], v[28:31]
    s_waitcnt lgkmcnt(15)
    v_mfma_f32_16x16x32_bf16 v[0:3], v[128:131], v[152:155], v[0:3]
    v_mfma_f32_16x16x32_bf16 v[8:11], v[132:135], v[152:155], v[8:11]
    v_mfma_f32_16x16x32_bf16 v[16:19], v[136:139], v[152:155], v[16:19]
    v_mfma_f32_16x16x32_bf16 v[24:27], v[140:143], v[152:155], v[24:27]
    v_mfma_f32_16x16x32_bf16 v[4:7], v[128:131], v[156:159], v[4:7]
    v_mfma_f32_16x16x32_bf16 v[12:15], v[132:135], v[156:159], v[12:15]
    v_mfma_f32_16x16x32_bf16 v[20:23], v[136:139], v[156:159], v[20:23]
    v_mfma_f32_16x16x32_bf16 v[28:31], v[140:143], v[156:159], v[28:31]
    s_waitcnt lgkmcnt(11)
    v_mfma_f32_16x16x32_bf16 v[0:3], v[176:179], v[192:195], v[0:3]
    ds_read_b128 v[144:147], v224 offset:8192
    ds_read_b128 v[148:151], v224 offset:10240
    v_mfma_f32_16x16x32_bf16 v[8:11], v[180:183], v[192:195], v[8:11]
    ds_read_b128 v[152:155], v225 offset:8192
    ds_read_b128 v[156:159], v225 offset:10240
    v_mfma_f32_16x16x32_bf16 v[16:19], v[184:187], v[192:195], v[16:19]
    v_mfma_f32_16x16x32_bf16 v[24:27], v[188:191], v[192:195], v[24:27]
    s_waitcnt lgkmcnt(14)
    v_mfma_f32_16x16x32_bf16 v[4:7], v[176:179], v[196:199], v[4:7]
    v_mfma_f32_16x16x32_bf16 v[12:15], v[180:183], v[196:199], v[12:15]
    v_mfma_f32_16x16x32_bf16 v[20:23], v[184:187], v[196:199], v[20:23]
    v_mfma_f32_16x16x32_bf16 v[28:31], v[188:191], v[196:199], v[28:31]
    s_waitcnt lgkmcnt(5)
    v_mfma_f32_16x16x32_bf16 v[0:3], v[208:211], v[200:203], v[0:3]
    v_mfma_f32_16x16x32_bf16 v[8:11], v[212:215], v[200:203], v[8:11]
    v_mfma_f32_16x16x32_bf16 v[16:19], v[216:219], v[200:203], v[16:19]
    v_mfma_f32_16x16x32_bf16 v[24:27], v[220:223], v[200:203], v[24:27]
    s_waitcnt lgkmcnt(4)
    v_mfma_f32_16x16x32_bf16 v[4:7], v[208:211], v[204:207], v[4:7]
    v_mfma_f32_16x16x32_bf16 v[12:15], v[212:215], v[204:207], v[12:15]
    v_mfma_f32_16x16x32_bf16 v[20:23], v[216:219], v[204:207], v[20:23]
    v_mfma_f32_16x16x32_bf16 v[28:31], v[220:223], v[204:207], v[28:31]
    s_waitcnt lgkmcnt(3)
    v_mfma_f32_16x16x32_bf16 v[64:67], v[160:163], v[144:147], v[64:67]
    ds_read_b128 v[192:195], v248 offset:8192
    v_mfma_f32_16x16x32_bf16 v[72:75], v[164:167], v[144:147], v[72:75]
    ds_read_b128 v[196:199], v248 offset:10240
    v_cvt_pk_bf16_f32 v0, v0, v1
    v_mfma_f32_16x16x32_bf16 v[80:83], v[168:171], v[144:147], v[80:83]
    ds_read_b128 v[200:203], v249 offset:8192
    v_cvt_pk_bf16_f32 v1, v2, v3
    v_mfma_f32_16x16x32_bf16 v[88:91], v[172:175], v[144:147], v[88:91]
    ds_read_b128 v[204:207], v249 offset:10240
    v_cvt_pk_bf16_f32 v2, v4, v5
    s_waitcnt lgkmcnt(6)
    v_mfma_f32_16x16x32_bf16 v[68:71], v[160:163], v[148:151], v[68:71]
    v_cvt_pk_bf16_f32 v3, v6, v7
    v_cvt_pk_bf16_f32 v8, v8, v9
    v_mfma_f32_16x16x32_bf16 v[76:79], v[164:167], v[148:151], v[76:79]
    v_cvt_pk_bf16_f32 v9, v10, v11
    v_cvt_pk_bf16_f32 v10, v12, v13
    v_mfma_f32_16x16x32_bf16 v[84:87], v[168:171], v[148:151], v[84:87]
    v_cvt_pk_bf16_f32 v11, v14, v15
    s_xor_b32 s41, s71, 0
    v_mfma_f32_16x16x32_bf16 v[92:95], v[172:175], v[148:151], v[92:95]
    s_mul_i32 s41, s60, s41
    s_add_u32 s41, s41, s58
    s_waitcnt lgkmcnt(5)
    v_mfma_f32_16x16x32_bf16 v[64:67], v[128:131], v[152:155], v[64:67]
    v_permlane16_swap_b32 v0, v2
    v_permlane16_swap_b32 v1, v3
    v_mfma_f32_16x16x32_bf16 v[72:75], v[132:135], v[152:155], v[72:75]
    v_permlane16_swap_b32 v8, v10
    v_permlane16_swap_b32 v9, v11
    v_mfma_f32_16x16x32_bf16 v[80:83], v[136:139], v[152:155], v[80:83]
    buffer_store_dwordx4 v[0:3], v230, s[64:67], s41 offen offset:0 sc1
    buffer_store_dwordx4 v[8:11], v230, s[64:67], s41 offen offset:1024 sc1
    v_mfma_f32_16x16x32_bf16 v[88:91], v[140:143], v[152:155], v[88:91]
    v_cvt_pk_bf16_f32 v16, v16, v17
    v_cvt_pk_bf16_f32 v17, v18, v19
    s_waitcnt lgkmcnt(4)
    v_mfma_f32_16x16x32_bf16 v[68:71], v[128:131], v[156:159], v[68:71]
    v_cvt_pk_bf16_f32 v18, v20, v21
    v_cvt_pk_bf16_f32 v19, v22, v23
    v_mfma_f32_16x16x32_bf16 v[76:79], v[132:135], v[156:159], v[76:79]
    v_cvt_pk_bf16_f32 v24, v24, v25
    v_cvt_pk_bf16_f32 v25, v26, v27
    v_mfma_f32_16x16x32_bf16 v[84:87], v[136:139], v[156:159], v[84:87]
    v_cvt_pk_bf16_f32 v26, v28, v29
    v_cvt_pk_bf16_f32 v27, v30, v31
    v_mfma_f32_16x16x32_bf16 v[92:95], v[140:143], v[156:159], v[92:95]
    s_add_u32 s41, s41, s59
    v_permlane16_swap_b32 v16, v18
    s_waitcnt lgkmcnt(3)
    v_mfma_f32_16x16x32_bf16 v[64:67], v[176:179], v[192:195], v[64:67]
    ds_read_b128 v[144:147], v224 offset:4096
    v_permlane16_swap_b32 v17, v19
    v_mfma_f32_16x16x32_bf16 v[72:75], v[180:183], v[192:195], v[72:75]
    ds_read_b128 v[148:151], v224 offset:6144
    v_permlane16_swap_b32 v24, v26
    v_mfma_f32_16x16x32_bf16 v[80:83], v[184:187], v[192:195], v[80:83]
    ds_read_b128 v[152:155], v225 offset:4096
    v_permlane16_swap_b32 v25, v27
    v_mfma_f32_16x16x32_bf16 v[88:91], v[188:191], v[192:195], v[88:91]
    ds_read_b128 v[156:159], v225 offset:6144
    buffer_store_dwordx4 v[16:19], v230, s[64:67], s41 offen offset:0 sc1
    s_waitcnt lgkmcnt(6)
    v_mfma_f32_16x16x32_bf16 v[68:71], v[176:179], v[196:199], v[68:71]
    buffer_store_dwordx4 v[24:27], v230, s[64:67], s41 offen offset:1024 sc1
    v_mfma_f32_16x16x32_bf16 v[76:79], v[180:183], v[196:199], v[76:79]
    v_mfma_f32_16x16x32_bf16 v[84:87], v[184:187], v[196:199], v[84:87]
    v_mfma_f32_16x16x32_bf16 v[92:95], v[188:191], v[196:199], v[92:95]
    s_waitcnt lgkmcnt(5)
    v_mfma_f32_16x16x32_bf16 v[64:67], v[208:211], v[200:203], v[64:67]
    v_mfma_f32_16x16x32_bf16 v[72:75], v[212:215], v[200:203], v[72:75]
    v_mfma_f32_16x16x32_bf16 v[80:83], v[216:219], v[200:203], v[80:83]
    v_mfma_f32_16x16x32_bf16 v[88:91], v[220:223], v[200:203], v[88:91]
    s_waitcnt lgkmcnt(4)
    v_mfma_f32_16x16x32_bf16 v[68:71], v[208:211], v[204:207], v[68:71]
    v_mfma_f32_16x16x32_bf16 v[76:79], v[212:215], v[204:207], v[76:79]
    v_mfma_f32_16x16x32_bf16 v[84:87], v[216:219], v[204:207], v[84:87]
    v_mfma_f32_16x16x32_bf16 v[92:95], v[220:223], v[204:207], v[92:95]
    s_barrier
    s_waitcnt lgkmcnt(3)
    v_mfma_f32_16x16x32_bf16 v[32:35], v[160:163], v[144:147], v[32:35]
    ds_read_b128 v[192:195], v248 offset:4096
    v_mfma_f32_16x16x32_bf16 v[40:43], v[164:167], v[144:147], v[40:43]
    ds_read_b128 v[196:199], v248 offset:6144
    v_cvt_pk_bf16_f32 v64, v64, v65
    v_mfma_f32_16x16x32_bf16 v[48:51], v[168:171], v[144:147], v[48:51]
    ds_read_b128 v[200:203], v249 offset:4096
    v_cvt_pk_bf16_f32 v65, v66, v67
    v_mfma_f32_16x16x32_bf16 v[56:59], v[172:175], v[144:147], v[56:59]
    ds_read_b128 v[204:207], v249 offset:6144
    v_cvt_pk_bf16_f32 v66, v68, v69
    s_waitcnt lgkmcnt(6)
    v_mfma_f32_16x16x32_bf16 v[36:39], v[160:163], v[148:151], v[36:39]
    v_cvt_pk_bf16_f32 v67, v70, v71
    v_cvt_pk_bf16_f32 v72, v72, v73
    v_mfma_f32_16x16x32_bf16 v[44:47], v[164:167], v[148:151], v[44:47]
    v_cvt_pk_bf16_f32 v73, v74, v75
    v_cvt_pk_bf16_f32 v74, v76, v77
    v_mfma_f32_16x16x32_bf16 v[52:55], v[168:171], v[148:151], v[52:55]
    v_cvt_pk_bf16_f32 v75, v78, v79
    s_xor_b32 s41, s71, 2
    v_mfma_f32_16x16x32_bf16 v[60:63], v[172:175], v[148:151], v[60:63]
    s_mul_i32 s41, s60, s41
    s_add_u32 s41, s41, s58
    s_waitcnt lgkmcnt(5)
    v_mfma_f32_16x16x32_bf16 v[32:35], v[128:131], v[152:155], v[32:35]
    v_permlane16_swap_b32 v64, v66
    v_permlane16_swap_b32 v65, v67
    v_mfma_f32_16x16x32_bf16 v[40:43], v[132:135], v[152:155], v[40:43]
    v_permlane16_swap_b32 v72, v74
    v_permlane16_swap_b32 v73, v75
    v_mfma_f32_16x16x32_bf16 v[48:51], v[136:139], v[152:155], v[48:51]
    buffer_store_dwordx4 v[64:67], v230, s[64:67], s41 offen offset:0 sc1
    buffer_store_dwordx4 v[72:75], v230, s[64:67], s41 offen offset:1024 sc1
    v_mfma_f32_16x16x32_bf16 v[56:59], v[140:143], v[152:155], v[56:59]
    v_cvt_pk_bf16_f32 v80, v80, v81
    v_cvt_pk_bf16_f32 v81, v82, v83
    s_waitcnt lgkmcnt(4)
    v_mfma_f32_16x16x32_bf16 v[36:39], v[128:131], v[156:159], v[36:39]
    v_cvt_pk_bf16_f32 v82, v84, v85
    v_cvt_pk_bf16_f32 v83, v86, v87
    v_mfma_f32_16x16x32_bf16 v[44:47], v[132:135], v[156:159], v[44:47]
    v_cvt_pk_bf16_f32 v88, v88, v89
    v_cvt_pk_bf16_f32 v89, v90, v91
    v_mfma_f32_16x16x32_bf16 v[52:55], v[136:139], v[156:159], v[52:55]
    v_cvt_pk_bf16_f32 v90, v92, v93
    v_cvt_pk_bf16_f32 v91, v94, v95
    v_mfma_f32_16x16x32_bf16 v[60:63], v[140:143], v[156:159], v[60:63]
    s_add_u32 s41, s41, s59
    v_permlane16_swap_b32 v80, v82
    s_waitcnt lgkmcnt(3)
    v_mfma_f32_16x16x32_bf16 v[32:35], v[176:179], v[192:195], v[32:35]
    ds_read_b64_tr_b16 v[232:233], v231 offset:0
    v_permlane16_swap_b32 v81, v83
    v_mfma_f32_16x16x32_bf16 v[40:43], v[180:183], v[192:195], v[40:43]
    ds_read_b64_tr_b16 v[234:235], v231 offset:256
    v_permlane16_swap_b32 v88, v90
    v_mfma_f32_16x16x32_bf16 v[48:51], v[184:187], v[192:195], v[48:51]
    ds_read_b64_tr_b16 v[236:237], v231 offset:2048
    v_permlane16_swap_b32 v89, v91
    v_mfma_f32_16x16x32_bf16 v[56:59], v[188:191], v[192:195], v[56:59]
    ds_read_b64_tr_b16 v[238:239], v231 offset:2304
    buffer_store_dwordx4 v[80:83], v230, s[64:67], s41 offen offset:0 sc1
    s_waitcnt lgkmcnt(6)
    v_mfma_f32_16x16x32_bf16 v[36:39], v[176:179], v[196:199], v[36:39]
    ds_read_b128 v[144:147], v224 offset:12288
    buffer_store_dwordx4 v[88:91], v230, s[64:67], s41 offen offset:1024 sc1
    v_mfma_f32_16x16x32_bf16 v[44:47], v[180:183], v[196:199], v[44:47]
    ds_read_b128 v[148:151], v224 offset:14336
    ds_read_b128 v[152:155], v225 offset:12288
    v_mfma_f32_16x16x32_bf16 v[52:55], v[184:187], v[196:199], v[52:55]
    ds_read_b128 v[156:159], v225 offset:14336
    v_mfma_f32_16x16x32_bf16 v[60:63], v[188:191], v[196:199], v[60:63]
    s_waitcnt lgkmcnt(9)
    v_mfma_f32_16x16x32_bf16 v[32:35], v[208:211], v[200:203], v[32:35]
    v_mfma_f32_16x16x32_bf16 v[40:43], v[212:215], v[200:203], v[40:43]
    v_mfma_f32_16x16x32_bf16 v[48:51], v[216:219], v[200:203], v[48:51]
    v_mfma_f32_16x16x32_bf16 v[56:59], v[220:223], v[200:203], v[56:59]
    s_waitcnt lgkmcnt(8)
    v_mfma_f32_16x16x32_bf16 v[36:39], v[208:211], v[204:207], v[36:39]
    v_mfma_f32_16x16x32_bf16 v[44:47], v[212:215], v[204:207], v[44:47]
    v_mfma_f32_16x16x32_bf16 v[52:55], v[216:219], v[204:207], v[52:55]
    v_mfma_f32_16x16x32_bf16 v[60:63], v[220:223], v[204:207], v[60:63]
    s_waitcnt lgkmcnt(3)
    v_mfma_f32_16x16x32_bf16 v[96:99], v[160:163], v[144:147], v[96:99]
    ds_read_b128 v[192:195], v248 offset:12288
    v_mfma_f32_16x16x32_bf16 v[104:107], v[164:167], v[144:147], v[104:107]
    ds_read_b128 v[196:199], v248 offset:14336
    v_cvt_pk_bf16_f32 v32, v32, v33
    v_mfma_f32_16x16x32_bf16 v[112:115], v[168:171], v[144:147], v[112:115]
    ds_read_b128 v[200:203], v249 offset:12288
    v_cvt_pk_bf16_f32 v33, v34, v35
    v_mfma_f32_16x16x32_bf16 v[120:123], v[172:175], v[144:147], v[120:123]
    ds_read_b128 v[204:207], v249 offset:14336
    v_cvt_pk_bf16_f32 v34, v36, v37
    s_waitcnt lgkmcnt(6)
    v_mfma_f32_16x16x32_bf16 v[100:103], v[160:163], v[148:151], v[100:103]
    v_cvt_pk_bf16_f32 v35, v38, v39
    v_cvt_pk_bf16_f32 v40, v40, v41
    v_mfma_f32_16x16x32_bf16 v[108:111], v[164:167], v[148:151], v[108:111]
    v_cvt_pk_bf16_f32 v41, v42, v43
    v_cvt_pk_bf16_f32 v42, v44, v45
    v_mfma_f32_16x16x32_bf16 v[116:119], v[168:171], v[148:151], v[116:119]
    v_cvt_pk_bf16_f32 v43, v46, v47
    s_xor_b32 s41, s71, 1
    v_mfma_f32_16x16x32_bf16 v[124:127], v[172:175], v[148:151], v[124:127]
    s_mul_i32 s41, s60, s41
    s_add_u32 s41, s41, s58
    v_mfma_f32_16x16x32_bf16 v[240:243], v[232:235], v[144:147], v[240:243]
    v_permlane16_swap_b32 v32, v34
    v_permlane16_swap_b32 v33, v35
    v_mfma_f32_16x16x32_bf16 v[244:247], v[232:235], v[148:151], v[244:247]
    v_permlane16_swap_b32 v40, v42
    v_permlane16_swap_b32 v41, v43
    s_waitcnt lgkmcnt(5)
    v_mfma_f32_16x16x32_bf16 v[96:99], v[128:131], v[152:155], v[96:99]
    ds_read_b64_tr_b16 v[232:233], v254 offset:0
    buffer_store_dwordx4 v[32:35], v230, s[64:67], s41 offen offset:0 sc1
    v_mfma_f32_16x16x32_bf16 v[104:107], v[132:135], v[152:155], v[104:107]
    ds_read_b64_tr_b16 v[234:235], v254 offset:256
    buffer_store_dwordx4 v[40:43], v230, s[64:67], s41 offen offset:1024 sc1
    v_mfma_f32_16x16x32_bf16 v[112:115], v[136:139], v[152:155], v[112:115]
    v_cvt_pk_bf16_f32 v48, v48, v49
    v_cvt_pk_bf16_f32 v49, v50, v51
    v_mfma_f32_16x16x32_bf16 v[120:123], v[140:143], v[152:155], v[120:123]
    v_cvt_pk_bf16_f32 v50, v52, v53
    v_cvt_pk_bf16_f32 v51, v54, v55
    s_waitcnt lgkmcnt(6)
    v_mfma_f32_16x16x32_bf16 v[100:103], v[128:131], v[156:159], v[100:103]
    v_cvt_pk_bf16_f32 v56, v56, v57
    v_cvt_pk_bf16_f32 v57, v58, v59
    v_mfma_f32_16x16x32_bf16 v[108:111], v[132:135], v[156:159], v[108:111]
    v_cvt_pk_bf16_f32 v58, v60, v61
    v_cvt_pk_bf16_f32 v59, v62, v63
    v_mfma_f32_16x16x32_bf16 v[116:119], v[136:139], v[156:159], v[116:119]
    s_add_u32 s41, s41, s59
    v_permlane16_swap_b32 v48, v50
    v_mfma_f32_16x16x32_bf16 v[124:127], v[140:143], v[156:159], v[124:127]
    v_permlane16_swap_b32 v49, v51
    v_permlane16_swap_b32 v56, v58
    v_mfma_f32_16x16x32_bf16 v[240:243], v[236:239], v[152:155], v[240:243]
    v_permlane16_swap_b32 v57, v59
    buffer_store_dwordx4 v[48:51], v230, s[64:67], s41 offen offset:0 sc1
    v_mfma_f32_16x16x32_bf16 v[244:247], v[236:239], v[156:159], v[244:247]
    buffer_store_dwordx4 v[56:59], v230, s[64:67], s41 offen offset:1024 sc1
    s_waitcnt lgkmcnt(5)
    v_mfma_f32_16x16x32_bf16 v[96:99], v[176:179], v[192:195], v[96:99]
    ds_read_b64_tr_b16 v[236:237], v254 offset:2048
    ds_read_b64_tr_b16 v[238:239], v254 offset:2304
    v_mfma_f32_16x16x32_bf16 v[104:107], v[180:183], v[192:195], v[104:107]
    v_mfma_f32_16x16x32_bf16 v[112:115], v[184:187], v[192:195], v[112:115]
    v_mfma_f32_16x16x32_bf16 v[120:123], v[188:191], v[192:195], v[120:123]
    s_waitcnt lgkmcnt(6)
    v_mfma_f32_16x16x32_bf16 v[100:103], v[176:179], v[196:199], v[100:103]
    v_mfma_f32_16x16x32_bf16 v[108:111], v[180:183], v[196:199], v[108:111]
    v_mfma_f32_16x16x32_bf16 v[116:119], v[184:187], v[196:199], v[116:119]
    v_mfma_f32_16x16x32_bf16 v[124:127], v[188:191], v[196:199], v[124:127]
    s_waitcnt lgkmcnt(2)
    v_mfma_f32_16x16x32_bf16 v[240:243], v[232:235], v[192:195], v[240:243]
    v_mfma_f32_16x16x32_bf16 v[244:247], v[232:235], v[196:199], v[244:247]
    v_mfma_f32_16x16x32_bf16 v[96:99], v[208:211], v[200:203], v[96:99]
    v_mfma_f32_16x16x32_bf16 v[104:107], v[212:215], v[200:203], v[104:107]
    v_mfma_f32_16x16x32_bf16 v[112:115], v[216:219], v[200:203], v[112:115]
    v_mfma_f32_16x16x32_bf16 v[120:123], v[220:223], v[200:203], v[120:123]
    v_mfma_f32_16x16x32_bf16 v[100:103], v[208:211], v[204:207], v[100:103]
    v_mfma_f32_16x16x32_bf16 v[108:111], v[212:215], v[204:207], v[108:111]
    v_mfma_f32_16x16x32_bf16 v[116:119], v[216:219], v[204:207], v[116:119]
    v_mfma_f32_16x16x32_bf16 v[124:127], v[220:223], v[204:207], v[124:127]
    s_waitcnt lgkmcnt(0)
    v_mfma_f32_16x16x32_bf16 v[240:243], v[236:239], v[200:203], v[240:243]
    v_mfma_f32_16x16x32_bf16 v[244:247], v[236:239], v[204:207], v[244:247]
    s_nop 0
    s_nop 0
    v_cvt_pk_bf16_f32 v96, v96, v97
    v_cvt_pk_bf16_f32 v97, v98, v99
    v_cvt_pk_bf16_f32 v98, v100, v101
    v_cvt_pk_bf16_f32 v99, v102, v103
    v_cvt_pk_bf16_f32 v104, v104, v105
    v_cvt_pk_bf16_f32 v105, v106, v107
    v_cvt_pk_bf16_f32 v106, v108, v109
    v_cvt_pk_bf16_f32 v107, v110, v111
    s_xor_b32 s41, s71, 3
    s_mul_i32 s41, s60, s41
    s_add_u32 s41, s41, s58
    v_permlane16_swap_b32 v96, v98
    v_permlane16_swap_b32 v97, v99
    v_permlane16_swap_b32 v104, v106
    v_permlane16_swap_b32 v105, v107
    buffer_store_dwordx4 v[96:99], v230, s[64:67], s41 offen offset:0 sc1
    s_nop 0
    buffer_store_dwordx4 v[104:107], v230, s[64:67], s41 offen offset:1024 sc1
    v_cvt_pk_bf16_f32 v112, v112, v113
    v_cvt_pk_bf16_f32 v113, v114, v115
    v_cvt_pk_bf16_f32 v114, v116, v117
    v_cvt_pk_bf16_f32 v115, v118, v119
    v_cvt_pk_bf16_f32 v120, v120, v121
    v_cvt_pk_bf16_f32 v121, v122, v123
    v_cvt_pk_bf16_f32 v122, v124, v125
    v_cvt_pk_bf16_f32 v123, v126, v127
    s_add_u32 s41, s41, s59
    v_permlane16_swap_b32 v112, v114
    v_permlane16_swap_b32 v113, v115
    v_permlane16_swap_b32 v120, v122
    v_permlane16_swap_b32 v121, v123
    buffer_store_dwordx4 v[112:115], v230, s[64:67], s41 offen offset:0 sc1
    s_nop 0
    buffer_store_dwordx4 v[120:123], v230, s[64:67], s41 offen offset:1024 sc1
    v_pk_mul_f32 v[240:241], v[240:241], s[42:43]
    v_pk_mul_f32 v[242:243], v[242:243], s[42:43]
    v_pk_mul_f32 v[244:245], v[244:245], s[42:43]
    v_pk_mul_f32 v[246:247], v[246:247], s[42:43]
    v_cvt_pk_bf16_f32 v240, v240, v241
    v_cvt_pk_bf16_f32 v241, v242, v243
    v_cvt_pk_bf16_f32 v242, v244, v245
    v_cvt_pk_bf16_f32 v243, v246, v247
    s_nop 0
    s_nop 0
    v_permlane16_swap_b32 v240, v242
    v_permlane16_swap_b32 v241, v243
    s_nop 0
    s_nop 0
    buffer_store_dwordx4 v[240:243], v230, s[64:67], s63 offen sc1
    s_branch p1_cdone
p1_end_bk:
p1_bvtype:
    s_cmp_lg_u32 s39, 0
    s_cbranch_scc1 p1_nopf_9
    s_getpc_b64 s[72:73]
pc_10:
    s_add_u32 s72, s72, p1_loop_bv-pc_10
    s_addc_u32 s73, s73, 0
    v_lshlrev_b32 v248, 3, v230
    v_min_u32 v248, p1_end_bv-p1_loop_bv-4, v248
    v_and_b32 v248, -4, v248
    v_add_co_u32 v248, vcc, s72, v248
    v_mov_b32 v249, s73
    v_addc_co_u32 v249, vcc, 0, v249, vcc
    global_load_dword v250, v[248:249], off
p1_nopf_9:
    v_lshrrev_b32 v232, 8, v230
    v_lshrrev_b32 v233, 6, v230
    v_and_b32 v233, 3, v233
    v_lshlrev_b32 v234, 3, v232
    v_add_u32 v234, v234, v233
    v_lshlrev_b32 v234, 6, v234
    s_lshr_b32 s41, s39, 1
    v_and_b32 v232, 1, v232
    v_xor_b32 v232, s41, v232
    v_lshlrev_b32 v232, 5, v232
    v_add_u32 v234, v234, v232
    v_lshrrev_b32 v235, 4, v230
    v_and_b32 v235, 3, v235
    v_lshlrev_b32 v235, 3, v235
    v_add_u32 v234, v234, v235
    v_add_u32 v231, 49152, v234
    v_mov_b32 v240, 0
    v_mov_b32 v241, 0
    v_mov_b32 v242, 0
    v_mov_b32 v243, 0
    v_mov_b32 v244, 0
    v_mov_b32 v245, 0
    v_mov_b32 v246, 0
    v_mov_b32 v247, 0
    s_mov_b32 s58, 0
    s_cmp_eq_u32 s38, 1
    s_cselect_b32 s58, 4194304, s58
    s_cmp_eq_u32 s38, 2
    s_cselect_b32 s58, 4196352, s58
    s_cmp_eq_u32 s38, 3
    s_cselect_b32 s58, 12582912, s58
    s_add_u32 s41, s38, 1
    s_and_b32 s41, s41, 2
    s_cmp_eq_u32 s41, 0
    s_mov_b32 s44, 262144
    s_cselect_b32 s59, 131072, s44
    s_mov_b32 s44, 4096
    s_cselect_b32 s60, 2048, s44
    s_mov_b32 s44, 1.0
    s_cselect_b32 s42, 0x3e8293ee, s44
    s_mov_b32 s43, s42
    s_lshl_b32 s41, s37, 2
    s_and_b32 s44, s39, 2
    s_add_u32 s41, s41, s44
    s_mul_i32 s41, s41, s59
    s_add_u32 s58, s58, s41
    s_lshl_b32 s41, s36, 3
    s_and_b32 s44, s39, 1
    s_lshl_b32 s44, s44, 2
    s_add_u32 s41, s41, s44
    s_mul_i32 s41, s41, s60
    s_add_u32 s58, s58, s41
    s_lshr_b32 s71, s37, 1
    s_lshl_b32 s41, s36, 1
    s_and_b32 s44, s39, 1
    s_add_u32 s41, s41, s44
    s_lshl_b32 s41, s41, 2
    s_xor_b32 s44, s71, 3
    s_add_u32 s41, s41, s44
    s_lshl_b32 s41, s41, 12
    s_lshr_b32 s44, s39, 1
    s_lshl_b32 s44, s44, 8
    s_add_u32 s41, s41, s44
    s_add_u32 s63, s41, 16779264
    s_mov_b32 s48, 13
    s_barrier
    ds_read_b64_tr_b16 v[160:161], v226 offset:0
    ds_read_b64_tr_b16 v[162:163], v226 offset:1024
    ds_read_b128 v[128:131], v224 offset:0
    ds_read_b64_tr_b16 v[164:165], v227 offset:0
    ds_read_b64_tr_b16 v[166:167], v227 offset:1024
    ds_read_b128 v[132:135], v224 offset:2048
    ds_read_b64_tr_b16 v[168:169], v228 offset:0
    ds_read_b64_tr_b16 v[170:171], v228 offset:1024
    ds_read_b64_tr_b16 v[172:173], v229 offset:0
    ds_read_b64_tr_b16 v[174:175], v229 offset:1024
    ds_read_b128 v[136:139], v224 offset:4096
    ds_read_b128 v[140:143], v224 offset:6144
    ds_read_b128 v[144:147], v224 offset:8192
    ds_read_b128 v[148:151], v224 offset:10240
    ds_read_b128 v[152:155], v224 offset:12288
    ds_read_b128 v[156:159], v224 offset:14336
    ds_read_b64_tr_b16 v[232:233], v231 offset:0
    ds_read_b64_tr_b16 v[234:235], v231 offset:256
p1_loop_bv:
    s_waitcnt lgkmcnt(0)
    v_mfma_f32_16x16x32_bf16 v[0:3], v[160:163], v[128:131], v[0:3]
    ds_read_b64_tr_b16 v[208:209], v226 offset:8192
    v_mfma_f32_16x16x32_bf16 v[8:11], v[164:167], v[128:131], v[8:11]
    ds_read_b64_tr_b16 v[210:211], v226 offset:9216
    v_mfma_f32_16x16x32_bf16 v[16:19], v[168:171], v[128:131], v[16:19]
    ds_read_b128 v[176:179], v225 offset:0
    v_mfma_f32_16x16x32_bf16 v[24:27], v[172:175], v[128:131], v[24:27]
    ds_read_b64_tr_b16 v[212:213], v227 offset:8192
    v_mfma_f32_16x16x32_bf16 v[4:7], v[160:163], v[132:135], v[4:7]
    ds_read_b64_tr_b16 v[214:215], v227 offset:9216
    v_mfma_f32_16x16x32_bf16 v[12:15], v[164:167], v[132:135], v[12:15]
    ds_read_b128 v[180:183], v225 offset:2048
    v_mfma_f32_16x16x32_bf16 v[20:23], v[168:171], v[132:135], v[20:23]
    ds_read_b64_tr_b16 v[216:217], v228 offset:8192
    v_mfma_f32_16x16x32_bf16 v[28:31], v[172:175], v[132:135], v[28:31]
    ds_read_b64_tr_b16 v[218:219], v228 offset:9216
    v_mfma_f32_16x16x32_bf16 v[32:35], v[160:163], v[136:139], v[32:35]
    ds_read_b64_tr_b16 v[220:221], v229 offset:8192
    v_mfma_f32_16x16x32_bf16 v[40:43], v[164:167], v[136:139], v[40:43]
    ds_read_b64_tr_b16 v[222:223], v229 offset:9216
    v_mfma_f32_16x16x32_bf16 v[48:51], v[168:171], v[136:139], v[48:51]
    ds_read_b128 v[184:187], v225 offset:4096
    v_mfma_f32_16x16x32_bf16 v[56:59], v[172:175], v[136:139], v[56:59]
    ds_read_b128 v[188:191], v225 offset:6144
    v_mfma_f32_16x16x32_bf16 v[36:39], v[160:163], v[140:143], v[36:39]
    ds_read_b128 v[192:195], v225 offset:8192
    v_mfma_f32_16x16x32_bf16 v[44:47], v[164:167], v[140:143], v[44:47]
    ds_read_b128 v[196:199], v225 offset:10240
    v_mfma_f32_16x16x32_bf16 v[52:55], v[168:171], v[140:143], v[52:55]
    ds_read_b128 v[200:203], v225 offset:12288
    v_mfma_f32_16x16x32_bf16 v[60:63], v[172:175], v[140:143], v[60:63]
    ds_read_b128 v[204:207], v225 offset:14336
    v_mfma_f32_16x16x32_bf16 v[64:67], v[160:163], v[144:147], v[64:67]
    ds_read_b64_tr_b16 v[236:237], v231 offset:2048
    v_mfma_f32_16x16x32_bf16 v[72:75], v[164:167], v[144:147], v[72:75]
    ds_read_b64_tr_b16 v[238:239], v231 offset:2304
    v_mfma_f32_16x16x32_bf16 v[80:83], v[168:171], v[144:147], v[80:83]
    v_mfma_f32_16x16x32_bf16 v[88:91], v[172:175], v[144:147], v[88:91]
    v_mfma_f32_16x16x32_bf16 v[68:71], v[160:163], v[148:151], v[68:71]
    v_mfma_f32_16x16x32_bf16 v[76:79], v[164:167], v[148:151], v[76:79]
    v_mfma_f32_16x16x32_bf16 v[84:87], v[168:171], v[148:151], v[84:87]
    v_mfma_f32_16x16x32_bf16 v[92:95], v[172:175], v[148:151], v[92:95]
    v_mfma_f32_16x16x32_bf16 v[96:99], v[160:163], v[152:155], v[96:99]
    v_mfma_f32_16x16x32_bf16 v[104:107], v[164:167], v[152:155], v[104:107]
    v_mfma_f32_16x16x32_bf16 v[112:115], v[168:171], v[152:155], v[112:115]
    v_mfma_f32_16x16x32_bf16 v[120:123], v[172:175], v[152:155], v[120:123]
    v_mfma_f32_16x16x32_bf16 v[100:103], v[160:163], v[156:159], v[100:103]
    v_mfma_f32_16x16x32_bf16 v[108:111], v[164:167], v[156:159], v[108:111]
    v_mfma_f32_16x16x32_bf16 v[116:119], v[168:171], v[156:159], v[116:119]
    v_mfma_f32_16x16x32_bf16 v[124:127], v[172:175], v[156:159], v[124:127]
    v_mfma_f32_16x16x32_bf16 v[240:243], v[152:155], v[232:235], v[240:243]
    v_mfma_f32_16x16x32_bf16 v[244:247], v[156:159], v[232:235], v[244:247]
    s_waitcnt lgkmcnt(0)
    v_mfma_f32_16x16x32_bf16 v[0:3], v[208:211], v[176:179], v[0:3]
    v_mfma_f32_16x16x32_bf16 v[8:11], v[212:215], v[176:179], v[8:11]
    v_mfma_f32_16x16x32_bf16 v[16:19], v[216:219], v[176:179], v[16:19]
    v_mfma_f32_16x16x32_bf16 v[24:27], v[220:223], v[176:179], v[24:27]
    v_mfma_f32_16x16x32_bf16 v[4:7], v[208:211], v[180:183], v[4:7]
    v_mfma_f32_16x16x32_bf16 v[12:15], v[212:215], v[180:183], v[12:15]
    v_mfma_f32_16x16x32_bf16 v[20:23], v[216:219], v[180:183], v[20:23]
    v_mfma_f32_16x16x32_bf16 v[28:31], v[220:223], v[180:183], v[28:31]
    s_add_u32 s46, s46, 53248
    s_mov_b32 s47, 53248
    s_cmp_eq_u32 s46, 159744
    s_cselect_b32 s47, 4294860800, s47
    s_cselect_b32 s46, 0, s46
    v_add_u32 v224, s47, v224
    v_add_u32 v225, s47, v225
    v_add_u32 v226, s47, v226
    v_add_u32 v227, s47, v227
    v_add_u32 v228, s47, v228
    v_add_u32 v229, s47, v229
    v_add_u32 v231, s47, v231
    s_barrier
    v_mfma_f32_16x16x32_bf16 v[32:35], v[208:211], v[184:187], v[32:35]
    ds_read_b64_tr_b16 v[160:161], v226 offset:0
    v_mfma_f32_16x16x32_bf16 v[40:43], v[212:215], v[184:187], v[40:43]
    ds_read_b64_tr_b16 v[162:163], v226 offset:1024
    v_mfma_f32_16x16x32_bf16 v[48:51], v[216:219], v[184:187], v[48:51]
    ds_read_b128 v[128:131], v224 offset:0
    v_mfma_f32_16x16x32_bf16 v[56:59], v[220:223], v[184:187], v[56:59]
    ds_read_b64_tr_b16 v[164:165], v227 offset:0
    v_mfma_f32_16x16x32_bf16 v[36:39], v[208:211], v[188:191], v[36:39]
    ds_read_b64_tr_b16 v[166:167], v227 offset:1024
    v_mfma_f32_16x16x32_bf16 v[44:47], v[212:215], v[188:191], v[44:47]
    ds_read_b128 v[132:135], v224 offset:2048
    v_mfma_f32_16x16x32_bf16 v[52:55], v[216:219], v[188:191], v[52:55]
    ds_read_b64_tr_b16 v[168:169], v228 offset:0
    v_mfma_f32_16x16x32_bf16 v[60:63], v[220:223], v[188:191], v[60:63]
    ds_read_b64_tr_b16 v[170:171], v228 offset:1024
    v_mfma_f32_16x16x32_bf16 v[64:67], v[208:211], v[192:195], v[64:67]
    ds_read_b64_tr_b16 v[172:173], v229 offset:0
    v_mfma_f32_16x16x32_bf16 v[72:75], v[212:215], v[192:195], v[72:75]
    ds_read_b64_tr_b16 v[174:175], v229 offset:1024
    v_mfma_f32_16x16x32_bf16 v[80:83], v[216:219], v[192:195], v[80:83]
    ds_read_b128 v[136:139], v224 offset:4096
    v_mfma_f32_16x16x32_bf16 v[88:91], v[220:223], v[192:195], v[88:91]
    ds_read_b128 v[140:143], v224 offset:6144
    v_mfma_f32_16x16x32_bf16 v[68:71], v[208:211], v[196:199], v[68:71]
    ds_read_b128 v[144:147], v224 offset:8192
    v_mfma_f32_16x16x32_bf16 v[76:79], v[212:215], v[196:199], v[76:79]
    ds_read_b128 v[148:151], v224 offset:10240
    v_mfma_f32_16x16x32_bf16 v[84:87], v[216:219], v[196:199], v[84:87]
    ds_read_b128 v[152:155], v224 offset:12288
    v_mfma_f32_16x16x32_bf16 v[92:95], v[220:223], v[196:199], v[92:95]
    ds_read_b128 v[156:159], v224 offset:14336
    v_mfma_f32_16x16x32_bf16 v[96:99], v[208:211], v[200:203], v[96:99]
    ds_read_b64_tr_b16 v[232:233], v231 offset:0
    v_mfma_f32_16x16x32_bf16 v[104:107], v[212:215], v[200:203], v[104:107]
    ds_read_b64_tr_b16 v[234:235], v231 offset:256
    v_mfma_f32_16x16x32_bf16 v[112:115], v[216:219], v[200:203], v[112:115]
    v_mfma_f32_16x16x32_bf16 v[120:123], v[220:223], v[200:203], v[120:123]
    v_mfma_f32_16x16x32_bf16 v[100:103], v[208:211], v[204:207], v[100:103]
    v_mfma_f32_16x16x32_bf16 v[108:111], v[212:215], v[204:207], v[108:111]
    v_mfma_f32_16x16x32_bf16 v[116:119], v[216:219], v[204:207], v[116:119]
    v_mfma_f32_16x16x32_bf16 v[124:127], v[220:223], v[204:207], v[124:127]
    v_mfma_f32_16x16x32_bf16 v[240:243], v[200:203], v[236:239], v[240:243]
    v_mfma_f32_16x16x32_bf16 v[244:247], v[204:207], v[236:239], v[244:247]
    s_sub_u32 s48, s48, 1
    s_cmp_lg_u32 s48, 0
    s_cbranch_scc1 p1_loop_bv
    s_waitcnt lgkmcnt(0) vmcnt(0)
    v_mfma_f32_16x16x32_bf16 v[0:3], v[160:163], v[128:131], v[0:3]
    ds_read_b64_tr_b16 v[208:209], v226 offset:8192
    v_mfma_f32_16x16x32_bf16 v[8:11], v[164:167], v[128:131], v[8:11]
    ds_read_b64_tr_b16 v[210:211], v226 offset:9216
    v_mfma_f32_16x16x32_bf16 v[16:19], v[168:171], v[128:131], v[16:19]
    ds_read_b128 v[176:179], v225 offset:0
    v_mfma_f32_16x16x32_bf16 v[24:27], v[172:175], v[128:131], v[24:27]
    ds_read_b64_tr_b16 v[212:213], v227 offset:8192
    v_mfma_f32_16x16x32_bf16 v[4:7], v[160:163], v[132:135], v[4:7]
    ds_read_b64_tr_b16 v[214:215], v227 offset:9216
    v_mfma_f32_16x16x32_bf16 v[12:15], v[164:167], v[132:135], v[12:15]
    ds_read_b128 v[180:183], v225 offset:2048
    v_mfma_f32_16x16x32_bf16 v[20:23], v[168:171], v[132:135], v[20:23]
    ds_read_b64_tr_b16 v[216:217], v228 offset:8192
    v_mfma_f32_16x16x32_bf16 v[28:31], v[172:175], v[132:135], v[28:31]
    ds_read_b64_tr_b16 v[218:219], v228 offset:9216
    v_mfma_f32_16x16x32_bf16 v[32:35], v[160:163], v[136:139], v[32:35]
    ds_read_b64_tr_b16 v[220:221], v229 offset:8192
    v_mfma_f32_16x16x32_bf16 v[40:43], v[164:167], v[136:139], v[40:43]
    ds_read_b64_tr_b16 v[222:223], v229 offset:9216
    v_mfma_f32_16x16x32_bf16 v[48:51], v[168:171], v[136:139], v[48:51]
    ds_read_b128 v[184:187], v225 offset:4096
    v_mfma_f32_16x16x32_bf16 v[56:59], v[172:175], v[136:139], v[56:59]
    ds_read_b128 v[188:191], v225 offset:6144
    v_mfma_f32_16x16x32_bf16 v[36:39], v[160:163], v[140:143], v[36:39]
    ds_read_b128 v[192:195], v225 offset:8192
    v_mfma_f32_16x16x32_bf16 v[44:47], v[164:167], v[140:143], v[44:47]
    ds_read_b128 v[196:199], v225 offset:10240
    v_mfma_f32_16x16x32_bf16 v[52:55], v[168:171], v[140:143], v[52:55]
    ds_read_b128 v[200:203], v225 offset:12288
    v_mfma_f32_16x16x32_bf16 v[60:63], v[172:175], v[140:143], v[60:63]
    ds_read_b128 v[204:207], v225 offset:14336
    v_mfma_f32_16x16x32_bf16 v[64:67], v[160:163], v[144:147], v[64:67]
    ds_read_b64_tr_b16 v[236:237], v231 offset:2048
    v_mfma_f32_16x16x32_bf16 v[72:75], v[164:167], v[144:147], v[72:75]
    ds_read_b64_tr_b16 v[238:239], v231 offset:2304
    v_mfma_f32_16x16x32_bf16 v[80:83], v[168:171], v[144:147], v[80:83]
    v_mfma_f32_16x16x32_bf16 v[88:91], v[172:175], v[144:147], v[88:91]
    v_mfma_f32_16x16x32_bf16 v[68:71], v[160:163], v[148:151], v[68:71]
    v_mfma_f32_16x16x32_bf16 v[76:79], v[164:167], v[148:151], v[76:79]
    v_mfma_f32_16x16x32_bf16 v[84:87], v[168:171], v[148:151], v[84:87]
    v_mfma_f32_16x16x32_bf16 v[92:95], v[172:175], v[148:151], v[92:95]
    v_mfma_f32_16x16x32_bf16 v[96:99], v[160:163], v[152:155], v[96:99]
    v_mfma_f32_16x16x32_bf16 v[104:107], v[164:167], v[152:155], v[104:107]
    v_mfma_f32_16x16x32_bf16 v[112:115], v[168:171], v[152:155], v[112:115]
    v_mfma_f32_16x16x32_bf16 v[120:123], v[172:175], v[152:155], v[120:123]
    v_mfma_f32_16x16x32_bf16 v[100:103], v[160:163], v[156:159], v[100:103]
    v_mfma_f32_16x16x32_bf16 v[108:111], v[164:167], v[156:159], v[108:111]
    v_mfma_f32_16x16x32_bf16 v[116:119], v[168:171], v[156:159], v[116:119]
    v_mfma_f32_16x16x32_bf16 v[124:127], v[172:175], v[156:159], v[124:127]
    v_mfma_f32_16x16x32_bf16 v[240:243], v[152:155], v[232:235], v[240:243]
    v_mfma_f32_16x16x32_bf16 v[244:247], v[156:159], v[232:235], v[244:247]
    s_waitcnt lgkmcnt(0)
    v_mfma_f32_16x16x32_bf16 v[0:3], v[208:211], v[176:179], v[0:3]
    v_add_u32 v248, 4294914048, v224
    v_add_u32 v224, 53248, v224
    v_mfma_f32_16x16x32_bf16 v[8:11], v[212:215], v[176:179], v[8:11]
    v_add_u32 v249, 4294914048, v225
    v_add_u32 v225, 53248, v225
    v_mfma_f32_16x16x32_bf16 v[16:19], v[216:219], v[176:179], v[16:19]
    v_add_u32 v250, 4294914048, v226
    v_add_u32 v226, 53248, v226
    v_mfma_f32_16x16x32_bf16 v[24:27], v[220:223], v[176:179], v[24:27]
    v_add_u32 v251, 4294914048, v227
    v_add_u32 v227, 53248, v227
    v_mfma_f32_16x16x32_bf16 v[4:7], v[208:211], v[180:183], v[4:7]
    v_add_u32 v252, 4294914048, v228
    v_add_u32 v228, 53248, v228
    v_mfma_f32_16x16x32_bf16 v[12:15], v[212:215], v[180:183], v[12:15]
    v_add_u32 v253, 4294914048, v229
    v_add_u32 v229, 53248, v229
    v_mfma_f32_16x16x32_bf16 v[20:23], v[216:219], v[180:183], v[20:23]
    v_add_u32 v254, 4294914048, v231
    v_add_u32 v231, 53248, v231
    v_mfma_f32_16x16x32_bf16 v[28:31], v[220:223], v[180:183], v[28:31]
    s_barrier
    v_mfma_f32_16x16x32_bf16 v[32:35], v[208:211], v[184:187], v[32:35]
    ds_read_b64_tr_b16 v[160:161], v226 offset:0
    v_mfma_f32_16x16x32_bf16 v[40:43], v[212:215], v[184:187], v[40:43]
    ds_read_b64_tr_b16 v[162:163], v226 offset:1024
    v_mfma_f32_16x16x32_bf16 v[48:51], v[216:219], v[184:187], v[48:51]
    ds_read_b128 v[144:147], v224 offset:0
    v_mfma_f32_16x16x32_bf16 v[56:59], v[220:223], v[184:187], v[56:59]
    ds_read_b64_tr_b16 v[164:165], v227 offset:0
    v_mfma_f32_16x16x32_bf16 v[36:39], v[208:211], v[188:191], v[36:39]
    ds_read_b64_tr_b16 v[166:167], v227 offset:1024
    v_mfma_f32_16x16x32_bf16 v[44:47], v[212:215], v[188:191], v[44:47]
    ds_read_b128 v[148:151], v224 offset:2048
    v_mfma_f32_16x16x32_bf16 v[52:55], v[216:219], v[188:191], v[52:55]
    ds_read_b64_tr_b16 v[168:169], v228 offset:0
    v_mfma_f32_16x16x32_bf16 v[60:63], v[220:223], v[188:191], v[60:63]
    ds_read_b64_tr_b16 v[170:171], v228 offset:1024
    v_mfma_f32_16x16x32_bf16 v[64:67], v[208:211], v[192:195], v[64:67]
    ds_read_b64_tr_b16 v[172:173], v229 offset:0
    v_mfma_f32_16x16x32_bf16 v[72:75], v[212:215], v[192:195], v[72:75]
    ds_read_b64_tr_b16 v[174:175], v229 offset:1024
    v_mfma_f32_16x16x32_bf16 v[80:83], v[216:219], v[192:195], v[80:83]
    ds_read_b64_tr_b16 v[128:129], v226 offset:8192
    v_mfma_f32_16x16x32_bf16 v[88:91], v[220:223], v[192:195], v[88:91]
    ds_read_b64_tr_b16 v[130:131], v226 offset:9216
    v_mfma_f32_16x16x32_bf16 v[68:71], v[208:211], v[196:199], v[68:71]
    ds_read_b128 v[152:155], v225 offset:0
    v_mfma_f32_16x16x32_bf16 v[76:79], v[212:215], v[196:199], v[76:79]
    ds_read_b64_tr_b16 v[132:133], v227 offset:8192
    v_mfma_f32_16x16x32_bf16 v[84:87], v[216:219], v[196:199], v[84:87]
    ds_read_b64_tr_b16 v[134:135], v227 offset:9216
    v_mfma_f32_16x16x32_bf16 v[92:95], v[220:223], v[196:199], v[92:95]
    ds_read_b128 v[156:159], v225 offset:2048
    v_mfma_f32_16x16x32_bf16 v[96:99], v[208:211], v[200:203], v[96:99]
    ds_read_b64_tr_b16 v[136:137], v228 offset:8192
    v_mfma_f32_16x16x32_bf16 v[104:107], v[212:215], v[200:203], v[104:107]
    ds_read_b64_tr_b16 v[138:139], v228 offset:9216
    s_barrier
    v_mfma_f32_16x16x32_bf16 v[112:115], v[216:219], v[200:203], v[112:115]
    ds_read_b64_tr_b16 v[140:141], v229 offset:8192
    v_mfma_f32_16x16x32_bf16 v[120:123], v[220:223], v[200:203], v[120:123]
    ds_read_b64_tr_b16 v[142:143], v229 offset:9216
    v_mfma_f32_16x16x32_bf16 v[100:103], v[208:211], v[204:207], v[100:103]
    ds_read_b64_tr_b16 v[176:177], v250 offset:0
    v_mfma_f32_16x16x32_bf16 v[108:111], v[212:215], v[204:207], v[108:111]
    ds_read_b64_tr_b16 v[178:179], v250 offset:1024
    v_mfma_f32_16x16x32_bf16 v[116:119], v[216:219], v[204:207], v[116:119]
    ds_read_b64_tr_b16 v[180:181], v251 offset:0
    v_mfma_f32_16x16x32_bf16 v[124:127], v[220:223], v[204:207], v[124:127]
    ds_read_b64_tr_b16 v[182:183], v251 offset:1024
    v_mfma_f32_16x16x32_bf16 v[240:243], v[200:203], v[236:239], v[240:243]
    ds_read_b64_tr_b16 v[184:185], v252 offset:0
    v_mfma_f32_16x16x32_bf16 v[244:247], v[204:207], v[236:239], v[244:247]
    ds_read_b64_tr_b16 v[186:187], v252 offset:1024
    s_waitcnt lgkmcnt(15)
    v_mfma_f32_16x16x32_bf16 v[0:3], v[160:163], v[144:147], v[0:3]
    ds_read_b64_tr_b16 v[188:189], v253 offset:0
    ds_read_b64_tr_b16 v[190:191], v253 offset:1024
    v_mfma_f32_16x16x32_bf16 v[8:11], v[164:167], v[144:147], v[8:11]
    ds_read_b128 v[192:195], v248 offset:0
    ds_read_b128 v[196:199], v248 offset:2048
    v_mfma_f32_16x16x32_bf16 v[16:19], v[168:171], v[144:147], v[16:19]
    ds_read_b64_tr_b16 v[208:209], v250 offset:8192
    ds_read_b64_tr_b16 v[210:211], v250 offset:9216
    v_mfma_f32_16x16x32_bf16 v[24:27], v[172:175], v[144:147], v[24:27]
    ds_read_b64_tr_b16 v[212:213], v251 offset:8192
    ds_read_b64_tr_b16 v[214:215], v251 offset:9216
    v_mfma_f32_16x16x32_bf16 v[4:7], v[160:163], v[148:151], v[4:7]
    ds_read_b64_tr_b16 v[216:217], v252 offset:8192
    ds_read_b64_tr_b16 v[218:219], v252 offset:9216
    v_mfma_f32_16x16x32_bf16 v[12:15], v[164:167], v[148:151], v[12:15]
    ds_read_b64_tr_b16 v[220:221], v253 offset:8192
    ds_read_b64_tr_b16 v[222:223], v253 offset:9216
    v_mfma_f32_16x16x32_bf16 v[20:23], v[168:171], v[148:151], v[20:23]
    ds_read_b128 v[200:203], v249 offset:0
    ds_read_b128 v[204:207], v249 offset:2048
    v_mfma_f32_16x16x32_bf16 v[28:31], v[172:175], v[148:151], v[28:31]
    s_waitcnt lgkmcnt(15)
    v_mfma_f32_16x16x32_bf16 v[0:3], v[128:131], v[152:155], v[0:3]
    v_mfma_f32_16x16x32_bf16 v[8:11], v[132:135], v[152:155], v[8:11]
    v_mfma_f32_16x16x32_bf16 v[16:19], v[136:139], v[152:155], v[16:19]
    v_mfma_f32_16x16x32_bf16 v[24:27], v[140:143], v[152:155], v[24:27]
    v_mfma_f32_16x16x32_bf16 v[4:7], v[128:131], v[156:159], v[4:7]
    v_mfma_f32_16x16x32_bf16 v[12:15], v[132:135], v[156:159], v[12:15]
    v_mfma_f32_16x16x32_bf16 v[20:23], v[136:139], v[156:159], v[20:23]
    v_mfma_f32_16x16x32_bf16 v[28:31], v[140:143], v[156:159], v[28:31]
    s_waitcnt lgkmcnt(11)
    v_mfma_f32_16x16x32_bf16 v[0:3], v[176:179], v[192:195], v[0:3]
    ds_read_b128 v[144:147], v224 offset:8192
    ds_read_b128 v[148:151], v224 offset:10240
    v_mfma_f32_16x16x32_bf16 v[8:11], v[180:183], v[192:195], v[8:11]
    ds_read_b128 v[152:155], v225 offset:8192
    ds_read_b128 v[156:159], v225 offset:10240
    v_mfma_f32_16x16x32_bf16 v[16:19], v[184:187], v[192:195], v[16:19]
    v_mfma_f32_16x16x32_bf16 v[24:27], v[188:191], v[192:195], v[24:27]
    s_waitcnt lgkmcnt(14)
    v_mfma_f32_16x16x32_bf16 v[4:7], v[176:179], v[196:199], v[4:7]
    v_mfma_f32_16x16x32_bf16 v[12:15], v[180:183], v[196:199], v[12:15]
    v_mfma_f32_16x16x32_bf16 v[20:23], v[184:187], v[196:199], v[20:23]
    v_mfma_f32_16x16x32_bf16 v[28:31], v[188:191], v[196:199], v[28:31]
    s_waitcnt lgkmcnt(5)
    v_mfma_f32_16x16x32_bf16 v[0:3], v[208:211], v[200:203], v[0:3]
    v_mfma_f32_16x16x32_bf16 v[8:11], v[212:215], v[200:203], v[8:11]
    v_mfma_f32_16x16x32_bf16 v[16:19], v[216:219], v[200:203], v[16:19]
    v_mfma_f32_16x16x32_bf16 v[24:27], v[220:223], v[200:203], v[24:27]
    s_waitcnt lgkmcnt(4)
    v_mfma_f32_16x16x32_bf16 v[4:7], v[208:211], v[204:207], v[4:7]
    v_mfma_f32_16x16x32_bf16 v[12:15], v[212:215], v[204:207], v[12:15]
    v_mfma_f32_16x16x32_bf16 v[20:23], v[216:219], v[204:207], v[20:23]
    v_mfma_f32_16x16x32_bf16 v[28:31], v[220:223], v[204:207], v[28:31]
    s_waitcnt lgkmcnt(3)
    v_mfma_f32_16x16x32_bf16 v[64:67], v[160:163], v[144:147], v[64:67]
    ds_read_b128 v[192:195], v248 offset:8192
    v_mfma_f32_16x16x32_bf16 v[72:75], v[164:167], v[144:147], v[72:75]
    ds_read_b128 v[196:199], v248 offset:10240
    v_cvt_pk_bf16_f32 v0, v0, v1
    v_mfma_f32_16x16x32_bf16 v[80:83], v[168:171], v[144:147], v[80:83]
    ds_read_b128 v[200:203], v249 offset:8192
    v_cvt_pk_bf16_f32 v1, v2, v3
    v_mfma_f32_16x16x32_bf16 v[88:91], v[172:175], v[144:147], v[88:91]
    ds_read_b128 v[204:207], v249 offset:10240
    v_cvt_pk_bf16_f32 v2, v4, v5
    s_waitcnt lgkmcnt(6)
    v_mfma_f32_16x16x32_bf16 v[68:71], v[160:163], v[148:151], v[68:71]
    v_cvt_pk_bf16_f32 v3, v6, v7
    v_cvt_pk_bf16_f32 v8, v8, v9
    v_mfma_f32_16x16x32_bf16 v[76:79], v[164:167], v[148:151], v[76:79]
    v_cvt_pk_bf16_f32 v9, v10, v11
    v_cvt_pk_bf16_f32 v10, v12, v13
    v_mfma_f32_16x16x32_bf16 v[84:87], v[168:171], v[148:151], v[84:87]
    v_cvt_pk_bf16_f32 v11, v14, v15
    s_xor_b32 s41, s71, 0
    v_mfma_f32_16x16x32_bf16 v[92:95], v[172:175], v[148:151], v[92:95]
    s_mul_i32 s41, s60, s41
    s_add_u32 s41, s41, s58
    s_waitcnt lgkmcnt(5)
    v_mfma_f32_16x16x32_bf16 v[64:67], v[128:131], v[152:155], v[64:67]
    v_permlane16_swap_b32 v0, v2
    v_permlane16_swap_b32 v1, v3
    v_mfma_f32_16x16x32_bf16 v[72:75], v[132:135], v[152:155], v[72:75]
    v_permlane16_swap_b32 v8, v10
    v_permlane16_swap_b32 v9, v11
    v_mfma_f32_16x16x32_bf16 v[80:83], v[136:139], v[152:155], v[80:83]
    buffer_store_dwordx4 v[0:3], v230, s[64:67], s41 offen offset:0 sc1
    buffer_store_dwordx4 v[8:11], v230, s[64:67], s41 offen offset:1024 sc1
    v_mfma_f32_16x16x32_bf16 v[88:91], v[140:143], v[152:155], v[88:91]
    v_cvt_pk_bf16_f32 v16, v16, v17
    v_cvt_pk_bf16_f32 v17, v18, v19
    s_waitcnt lgkmcnt(4)
    v_mfma_f32_16x16x32_bf16 v[68:71], v[128:131], v[156:159], v[68:71]
    v_cvt_pk_bf16_f32 v18, v20, v21
    v_cvt_pk_bf16_f32 v19, v22, v23
    v_mfma_f32_16x16x32_bf16 v[76:79], v[132:135], v[156:159], v[76:79]
    v_cvt_pk_bf16_f32 v24, v24, v25
    v_cvt_pk_bf16_f32 v25, v26, v27
    v_mfma_f32_16x16x32_bf16 v[84:87], v[136:139], v[156:159], v[84:87]
    v_cvt_pk_bf16_f32 v26, v28, v29
    v_cvt_pk_bf16_f32 v27, v30, v31
    v_mfma_f32_16x16x32_bf16 v[92:95], v[140:143], v[156:159], v[92:95]
    s_add_u32 s41, s41, s59
    v_permlane16_swap_b32 v16, v18
    s_waitcnt lgkmcnt(3)
    v_mfma_f32_16x16x32_bf16 v[64:67], v[176:179], v[192:195], v[64:67]
    ds_read_b128 v[144:147], v224 offset:4096
    v_permlane16_swap_b32 v17, v19
    v_mfma_f32_16x16x32_bf16 v[72:75], v[180:183], v[192:195], v[72:75]
    ds_read_b128 v[148:151], v224 offset:6144
    v_permlane16_swap_b32 v24, v26
    v_mfma_f32_16x16x32_bf16 v[80:83], v[184:187], v[192:195], v[80:83]
    ds_read_b128 v[152:155], v225 offset:4096
    v_permlane16_swap_b32 v25, v27
    v_mfma_f32_16x16x32_bf16 v[88:91], v[188:191], v[192:195], v[88:91]
    ds_read_b128 v[156:159], v225 offset:6144
    buffer_store_dwordx4 v[16:19], v230, s[64:67], s41 offen offset:0 sc1
    s_waitcnt lgkmcnt(6)
    v_mfma_f32_16x16x32_bf16 v[68:71], v[176:179], v[196:199], v[68:71]
    buffer_store_dwordx4 v[24:27], v230, s[64:67], s41 offen offset:1024 sc1
    v_mfma_f32_16x16x32_bf16 v[76:79], v[180:183], v[196:199], v[76:79]
    v_mfma_f32_16x16x32_bf16 v[84:87], v[184:187], v[196:199], v[84:87]
    v_mfma_f32_16x16x32_bf16 v[92:95], v[188:191], v[196:199], v[92:95]
    s_waitcnt lgkmcnt(5)
    v_mfma_f32_16x16x32_bf16 v[64:67], v[208:211], v[200:203], v[64:67]
    v_mfma_f32_16x16x32_bf16 v[72:75], v[212:215], v[200:203], v[72:75]
    v_mfma_f32_16x16x32_bf16 v[80:83], v[216:219], v[200:203], v[80:83]
    v_mfma_f32_16x16x32_bf16 v[88:91], v[220:223], v[200:203], v[88:91]
    s_waitcnt lgkmcnt(4)
    v_mfma_f32_16x16x32_bf16 v[68:71], v[208:211], v[204:207], v[68:71]
    v_mfma_f32_16x16x32_bf16 v[76:79], v[212:215], v[204:207], v[76:79]
    v_mfma_f32_16x16x32_bf16 v[84:87], v[216:219], v[204:207], v[84:87]
    v_mfma_f32_16x16x32_bf16 v[92:95], v[220:223], v[204:207], v[92:95]
    s_barrier
    s_waitcnt lgkmcnt(3)
    v_mfma_f32_16x16x32_bf16 v[32:35], v[160:163], v[144:147], v[32:35]
    ds_read_b128 v[192:195], v248 offset:4096
    v_mfma_f32_16x16x32_bf16 v[40:43], v[164:167], v[144:147], v[40:43]
    ds_read_b128 v[196:199], v248 offset:6144
    v_cvt_pk_bf16_f32 v64, v64, v65
    v_mfma_f32_16x16x32_bf16 v[48:51], v[168:171], v[144:147], v[48:51]
    ds_read_b128 v[200:203], v249 offset:4096
    v_cvt_pk_bf16_f32 v65, v66, v67
    v_mfma_f32_16x16x32_bf16 v[56:59], v[172:175], v[144:147], v[56:59]
    ds_read_b128 v[204:207], v249 offset:6144
    v_cvt_pk_bf16_f32 v66, v68, v69
    s_waitcnt lgkmcnt(6)
    v_mfma_f32_16x16x32_bf16 v[36:39], v[160:163], v[148:151], v[36:39]
    v_cvt_pk_bf16_f32 v67, v70, v71
    v_cvt_pk_bf16_f32 v72, v72, v73
    v_mfma_f32_16x16x32_bf16 v[44:47], v[164:167], v[148:151], v[44:47]
    v_cvt_pk_bf16_f32 v73, v74, v75
    v_cvt_pk_bf16_f32 v74, v76, v77
    v_mfma_f32_16x16x32_bf16 v[52:55], v[168:171], v[148:151], v[52:55]
    v_cvt_pk_bf16_f32 v75, v78, v79
    s_xor_b32 s41, s71, 2
    v_mfma_f32_16x16x32_bf16 v[60:63], v[172:175], v[148:151], v[60:63]
    s_mul_i32 s41, s60, s41
    s_add_u32 s41, s41, s58
    s_waitcnt lgkmcnt(5)
    v_mfma_f32_16x16x32_bf16 v[32:35], v[128:131], v[152:155], v[32:35]
    v_permlane16_swap_b32 v64, v66
    v_permlane16_swap_b32 v65, v67
    v_mfma_f32_16x16x32_bf16 v[40:43], v[132:135], v[152:155], v[40:43]
    v_permlane16_swap_b32 v72, v74
    v_permlane16_swap_b32 v73, v75
    v_mfma_f32_16x16x32_bf16 v[48:51], v[136:139], v[152:155], v[48:51]
    buffer_store_dwordx4 v[64:67], v230, s[64:67], s41 offen offset:0 sc1
    buffer_store_dwordx4 v[72:75], v230, s[64:67], s41 offen offset:1024 sc1
    v_mfma_f32_16x16x32_bf16 v[56:59], v[140:143], v[152:155], v[56:59]
    v_cvt_pk_bf16_f32 v80, v80, v81
    v_cvt_pk_bf16_f32 v81, v82, v83
    s_waitcnt lgkmcnt(4)
    v_mfma_f32_16x16x32_bf16 v[36:39], v[128:131], v[156:159], v[36:39]
    v_cvt_pk_bf16_f32 v82, v84, v85
    v_cvt_pk_bf16_f32 v83, v86, v87
    v_mfma_f32_16x16x32_bf16 v[44:47], v[132:135], v[156:159], v[44:47]
    v_cvt_pk_bf16_f32 v88, v88, v89
    v_cvt_pk_bf16_f32 v89, v90, v91
    v_mfma_f32_16x16x32_bf16 v[52:55], v[136:139], v[156:159], v[52:55]
    v_cvt_pk_bf16_f32 v90, v92, v93
    v_cvt_pk_bf16_f32 v91, v94, v95
    v_mfma_f32_16x16x32_bf16 v[60:63], v[140:143], v[156:159], v[60:63]
    s_add_u32 s41, s41, s59
    v_permlane16_swap_b32 v80, v82
    s_waitcnt lgkmcnt(3)
    v_mfma_f32_16x16x32_bf16 v[32:35], v[176:179], v[192:195], v[32:35]
    ds_read_b64_tr_b16 v[232:233], v231 offset:0
    v_permlane16_swap_b32 v81, v83
    v_mfma_f32_16x16x32_bf16 v[40:43], v[180:183], v[192:195], v[40:43]
    ds_read_b64_tr_b16 v[234:235], v231 offset:256
    v_permlane16_swap_b32 v88, v90
    v_mfma_f32_16x16x32_bf16 v[48:51], v[184:187], v[192:195], v[48:51]
    ds_read_b64_tr_b16 v[236:237], v231 offset:2048
    v_permlane16_swap_b32 v89, v91
    v_mfma_f32_16x16x32_bf16 v[56:59], v[188:191], v[192:195], v[56:59]
    ds_read_b64_tr_b16 v[238:239], v231 offset:2304
    buffer_store_dwordx4 v[80:83], v230, s[64:67], s41 offen offset:0 sc1
    s_waitcnt lgkmcnt(6)
    v_mfma_f32_16x16x32_bf16 v[36:39], v[176:179], v[196:199], v[36:39]
    ds_read_b128 v[144:147], v224 offset:12288
    buffer_store_dwordx4 v[88:91], v230, s[64:67], s41 offen offset:1024 sc1
    v_mfma_f32_16x16x32_bf16 v[44:47], v[180:183], v[196:199], v[44:47]
    ds_read_b128 v[148:151], v224 offset:14336
    ds_read_b128 v[152:155], v225 offset:12288
    v_mfma_f32_16x16x32_bf16 v[52:55], v[184:187], v[196:199], v[52:55]
    ds_read_b128 v[156:159], v225 offset:14336
    v_mfma_f32_16x16x32_bf16 v[60:63], v[188:191], v[196:199], v[60:63]
    s_waitcnt lgkmcnt(9)
    v_mfma_f32_16x16x32_bf16 v[32:35], v[208:211], v[200:203], v[32:35]
    v_mfma_f32_16x16x32_bf16 v[40:43], v[212:215], v[200:203], v[40:43]
    v_mfma_f32_16x16x32_bf16 v[48:51], v[216:219], v[200:203], v[48:51]
    v_mfma_f32_16x16x32_bf16 v[56:59], v[220:223], v[200:203], v[56:59]
    s_waitcnt lgkmcnt(8)
    v_mfma_f32_16x16x32_bf16 v[36:39], v[208:211], v[204:207], v[36:39]
    v_mfma_f32_16x16x32_bf16 v[44:47], v[212:215], v[204:207], v[44:47]
    v_mfma_f32_16x16x32_bf16 v[52:55], v[216:219], v[204:207], v[52:55]
    v_mfma_f32_16x16x32_bf16 v[60:63], v[220:223], v[204:207], v[60:63]
    s_waitcnt lgkmcnt(3)
    v_mfma_f32_16x16x32_bf16 v[96:99], v[160:163], v[144:147], v[96:99]
    ds_read_b128 v[192:195], v248 offset:12288
    v_mfma_f32_16x16x32_bf16 v[104:107], v[164:167], v[144:147], v[104:107]
    ds_read_b128 v[196:199], v248 offset:14336
    v_cvt_pk_bf16_f32 v32, v32, v33
    v_mfma_f32_16x16x32_bf16 v[112:115], v[168:171], v[144:147], v[112:115]
    ds_read_b128 v[200:203], v249 offset:12288
    v_cvt_pk_bf16_f32 v33, v34, v35
    v_mfma_f32_16x16x32_bf16 v[120:123], v[172:175], v[144:147], v[120:123]
    ds_read_b128 v[204:207], v249 offset:14336
    v_cvt_pk_bf16_f32 v34, v36, v37
    s_waitcnt lgkmcnt(6)
    v_mfma_f32_16x16x32_bf16 v[100:103], v[160:163], v[148:151], v[100:103]
    v_cvt_pk_bf16_f32 v35, v38, v39
    v_cvt_pk_bf16_f32 v40, v40, v41
    v_mfma_f32_16x16x32_bf16 v[108:111], v[164:167], v[148:151], v[108:111]
    v_cvt_pk_bf16_f32 v41, v42, v43
    v_cvt_pk_bf16_f32 v42, v44, v45
    v_mfma_f32_16x16x32_bf16 v[116:119], v[168:171], v[148:151], v[116:119]
    v_cvt_pk_bf16_f32 v43, v46, v47
    s_xor_b32 s41, s71, 1
    v_mfma_f32_16x16x32_bf16 v[124:127], v[172:175], v[148:151], v[124:127]
    s_mul_i32 s41, s60, s41
    s_add_u32 s41, s41, s58
    v_mfma_f32_16x16x32_bf16 v[240:243], v[144:147], v[232:235], v[240:243]
    v_permlane16_swap_b32 v32, v34
    v_permlane16_swap_b32 v33, v35
    v_mfma_f32_16x16x32_bf16 v[244:247], v[148:151], v[232:235], v[244:247]
    v_permlane16_swap_b32 v40, v42
    v_permlane16_swap_b32 v41, v43
    s_waitcnt lgkmcnt(5)
    v_mfma_f32_16x16x32_bf16 v[96:99], v[128:131], v[152:155], v[96:99]
    ds_read_b64_tr_b16 v[232:233], v254 offset:0
    buffer_store_dwordx4 v[32:35], v230, s[64:67], s41 offen offset:0 sc1
    v_mfma_f32_16x16x32_bf16 v[104:107], v[132:135], v[152:155], v[104:107]
    ds_read_b64_tr_b16 v[234:235], v254 offset:256
    buffer_store_dwordx4 v[40:43], v230, s[64:67], s41 offen offset:1024 sc1
    v_mfma_f32_16x16x32_bf16 v[112:115], v[136:139], v[152:155], v[112:115]
    v_cvt_pk_bf16_f32 v48, v48, v49
    v_cvt_pk_bf16_f32 v49, v50, v51
    v_mfma_f32_16x16x32_bf16 v[120:123], v[140:143], v[152:155], v[120:123]
    v_cvt_pk_bf16_f32 v50, v52, v53
    v_cvt_pk_bf16_f32 v51, v54, v55
    s_waitcnt lgkmcnt(6)
    v_mfma_f32_16x16x32_bf16 v[100:103], v[128:131], v[156:159], v[100:103]
    v_cvt_pk_bf16_f32 v56, v56, v57
    v_cvt_pk_bf16_f32 v57, v58, v59
    v_mfma_f32_16x16x32_bf16 v[108:111], v[132:135], v[156:159], v[108:111]
    v_cvt_pk_bf16_f32 v58, v60, v61
    v_cvt_pk_bf16_f32 v59, v62, v63
    v_mfma_f32_16x16x32_bf16 v[116:119], v[136:139], v[156:159], v[116:119]
    s_add_u32 s41, s41, s59
    v_permlane16_swap_b32 v48, v50
    v_mfma_f32_16x16x32_bf16 v[124:127], v[140:143], v[156:159], v[124:127]
    v_permlane16_swap_b32 v49, v51
    v_permlane16_swap_b32 v56, v58
    v_mfma_f32_16x16x32_bf16 v[240:243], v[152:155], v[236:239], v[240:243]
    v_permlane16_swap_b32 v57, v59
    buffer_store_dwordx4 v[48:51], v230, s[64:67], s41 offen offset:0 sc1
    v_mfma_f32_16x16x32_bf16 v[244:247], v[156:159], v[236:239], v[244:247]
    buffer_store_dwordx4 v[56:59], v230, s[64:67], s41 offen offset:1024 sc1
    s_waitcnt lgkmcnt(5)
    v_mfma_f32_16x16x32_bf16 v[96:99], v[176:179], v[192:195], v[96:99]
    ds_read_b64_tr_b16 v[236:237], v254 offset:2048
    ds_read_b64_tr_b16 v[238:239], v254 offset:2304
    v_mfma_f32_16x16x32_bf16 v[104:107], v[180:183], v[192:195], v[104:107]
    v_mfma_f32_16x16x32_bf16 v[112:115], v[184:187], v[192:195], v[112:115]
    v_mfma_f32_16x16x32_bf16 v[120:123], v[188:191], v[192:195], v[120:123]
    s_waitcnt lgkmcnt(6)
    v_mfma_f32_16x16x32_bf16 v[100:103], v[176:179], v[196:199], v[100:103]
    v_mfma_f32_16x16x32_bf16 v[108:111], v[180:183], v[196:199], v[108:111]
    v_mfma_f32_16x16x32_bf16 v[116:119], v[184:187], v[196:199], v[116:119]
    v_mfma_f32_16x16x32_bf16 v[124:127], v[188:191], v[196:199], v[124:127]
    s_waitcnt lgkmcnt(2)
    v_mfma_f32_16x16x32_bf16 v[240:243], v[192:195], v[232:235], v[240:243]
    v_mfma_f32_16x16x32_bf16 v[244:247], v[196:199], v[232:235], v[244:247]
    v_mfma_f32_16x16x32_bf16 v[96:99], v[208:211], v[200:203], v[96:99]
    v_mfma_f32_16x16x32_bf16 v[104:107], v[212:215], v[200:203], v[104:107]
    v_mfma_f32_16x16x32_bf16 v[112:115], v[216:219], v[200:203], v[112:115]
    v_mfma_f32_16x16x32_bf16 v[120:123], v[220:223], v[200:203], v[120:123]
    v_mfma_f32_16x16x32_bf16 v[100:103], v[208:211], v[204:207], v[100:103]
    v_mfma_f32_16x16x32_bf16 v[108:111], v[212:215], v[204:207], v[108:111]
    v_mfma_f32_16x16x32_bf16 v[116:119], v[216:219], v[204:207], v[116:119]
    v_mfma_f32_16x16x32_bf16 v[124:127], v[220:223], v[204:207], v[124:127]
    s_waitcnt lgkmcnt(0)
    v_mfma_f32_16x16x32_bf16 v[240:243], v[200:203], v[236:239], v[240:243]
    v_mfma_f32_16x16x32_bf16 v[244:247], v[204:207], v[236:239], v[244:247]
    s_nop 0
    s_nop 0
    v_cvt_pk_bf16_f32 v96, v96, v97
    v_cvt_pk_bf16_f32 v97, v98, v99
    v_cvt_pk_bf16_f32 v98, v100, v101
    v_cvt_pk_bf16_f32 v99, v102, v103
    v_cvt_pk_bf16_f32 v104, v104, v105
    v_cvt_pk_bf16_f32 v105, v106, v107
    v_cvt_pk_bf16_f32 v106, v108, v109
    v_cvt_pk_bf16_f32 v107, v110, v111
    s_xor_b32 s41, s71, 3
    s_mul_i32 s41, s60, s41
    s_add_u32 s41, s41, s58
    v_permlane16_swap_b32 v96, v98
    v_permlane16_swap_b32 v97, v99
    v_permlane16_swap_b32 v104, v106
    v_permlane16_swap_b32 v105, v107
    buffer_store_dwordx4 v[96:99], v230, s[64:67], s41 offen offset:0 sc1
    s_nop 0
    buffer_store_dwordx4 v[104:107], v230, s[64:67], s41 offen offset:1024 sc1
    v_cvt_pk_bf16_f32 v112, v112, v113
    v_cvt_pk_bf16_f32 v113, v114, v115
    v_cvt_pk_bf16_f32 v114, v116, v117
    v_cvt_pk_bf16_f32 v115, v118, v119
    v_cvt_pk_bf16_f32 v120, v120, v121
    v_cvt_pk_bf16_f32 v121, v122, v123
    v_cvt_pk_bf16_f32 v122, v124, v125
    v_cvt_pk_bf16_f32 v123, v126, v127
    s_add_u32 s41, s41, s59
    v_permlane16_swap_b32 v112, v114
    v_permlane16_swap_b32 v113, v115
    v_permlane16_swap_b32 v120, v122
    v_permlane16_swap_b32 v121, v123
    buffer_store_dwordx4 v[112:115], v230, s[64:67], s41 offen offset:0 sc1
    s_nop 0
    buffer_store_dwordx4 v[120:123], v230, s[64:67], s41 offen offset:1024 sc1
    v_lshrrev_b32 v231, 8, v230
    v_lshlrev_b32 v231, 9, v231
    v_and_b32 v254, 0xf0, v230
    v_add_u32 v231, v254, v231
    v_cvt_pk_bf16_f32 v240, v240, v241
    v_cvt_pk_bf16_f32 v241, v242, v243
    v_cvt_pk_bf16_f32 v242, v244, v245
    v_cvt_pk_bf16_f32 v243, v246, v247
    s_nop 0
    s_nop 0
    v_permlane32_swap_b32 v240, v242
    v_permlane32_swap_b32 v241, v243
    s_nop 0
    s_nop 0
    buffer_store_dwordx4 v[240:243], v231, s[64:67], s63 offen sc1
    s_branch p1_cdone
p1_end_bv:
p1_cdone:
    s_endpgm
p1_end:
    s_endpgm
.globl attn_kernel
.p2align 8
.type attn_kernel,@function
attn_kernel:
    s_cmp_ge_u32 s2, 256
    s_cbranch_scc1 p2_end
    s_load_dwordx2 s[8:9], s[0:1], 80
    v_lshrrev_b32 v1, 6, v0
    v_and_b32 v0, 63, v0
    v_readfirstlane_b32 s18, v1
    s_and_b32 s16, s2, 31
    s_lshr_b32 s17, s2, 5
    v_lshlrev_b32 v127, 4, v0
    s_lshl_b32 s19, s17, 3
    s_add_u32 s19, s19, s18
    s_lshl_b32 s20, s18, 12
    v_add_u32 v136, s20, v127
    s_mov_b32 m0, s20
    s_mov_b32 s10, 0x2000000
    s_mov_b32 s11, 0x00020000
    s_lshl_b32 s20, s16, 17
    s_lshl_b32 s21, s19, 11
    s_add_u32 s22, s20, s21
    s_add_u32 s20, s22, 12582912
    s_mov_b32 s25, 16777216
    s_waitcnt lgkmcnt(0)
    buffer_load_dwordx4 v136, s[8:11], s25 offen offset:0 lds
    buffer_load_dwordx4 v136, s[8:11], s25 offen offset:1024 lds
    buffer_load_dwordx4 v136, s[8:11], s25 offen offset:2048 lds
    buffer_load_dwordx4 v136, s[8:11], s25 offen offset:3072 lds
    buffer_load_dwordx4 v[4:7], v127, s[8:11], s20 offen
    buffer_load_dwordx4 v[8:11], v127, s[8:11], s20 offen offset:1024
    s_load_dwordx2 s[6:7], s[0:1], 16
    s_load_dwordx2 s[70:71], s[0:1], 56
    s_add_u32 s25, s25, 32768
    s_lshl_b32 s20, s16, 18
    s_add_u32 s20, s20, 4194304
    s_add_u32 s12, s8, s20
    s_addc_u32 s13, s9, 0
    s_mov_b32 s14, 262144
    s_mov_b32 s15, 0x00020000
    s_mov_b32 s68, s22
    s_lshl_b32 s20, s17, 15
    s_sub_u32 s20, s20, 32768
    s_lshl_b32 s21, s18, 13
    s_add_u32 s20, s20, s21
    v_add_u32 v137, s20, v127
    v_add_u32 v138, 4096, v137
    v_mov_b32 v124, v127
    v_add_u32 v125, 32768, v127
    s_lshl_b32 s20, s18, 12
    s_add_u32 s20, s20, 98304
    v_add_u32 v126, s20, v127
    v_mov_b32 v139, 0xff800000
    v_and_b32 v140, 15, v0
    v_and_b32 v141, 2, v140
    v_cmp_eq_u32 vcc, 0, v141
    v_mov_b32 v142, 0x3f803f80
    v_and_b32 v141, 4, v140
    v_cndmask_b32 v142, 0, v142, vcc
    v_cmp_eq_u32 vcc, 0, v141
    v_and_b32 v141, 1, v140
    v_mov_b32 v143, 0x44444444
    v_cndmask_b32 v100, 0, v142, vcc
    v_cndmask_b32 v102, v142, 0, vcc
    v_cmp_eq_u32 vcc, 0, v141
    v_mov_b32 v101, v100
    v_mov_b32 v103, v102
    v_mov_b32 v104, 0xEEEEEEEE
    v_cndmask_b32 v104, v104, v143, vcc
    v_and_b32 v140, 31, v0
    v_lshrrev_b32 v141, 5, v0
    v_lshlrev_b32 v141, 2, v141
    v_sub_u32 v140, v140, v141
    v_cmp_le_i32 s[32:33], 0, v140
    v_cmp_le_i32 s[34:35], 1, v140
    v_cmp_le_i32 s[36:37], 2, v140
    v_cmp_le_i32 s[38:39], 3, v140
    v_cmp_le_i32 s[40:41], 8, v140
    v_cmp_le_i32 s[42:43], 9, v140
    v_cmp_le_i32 s[44:45], 10, v140
    v_cmp_le_i32 s[46:47], 11, v140
    v_cmp_le_i32 s[48:49], 16, v140
    v_cmp_le_i32 s[50:51], 17, v140
    v_cmp_le_i32 s[52:53], 18, v140
    v_cmp_le_i32 s[54:55], 19, v140
    v_cmp_le_i32 s[56:57], 24, v140
    v_cmp_le_i32 s[58:59], 25, v140
    v_cmp_le_i32 s[60:61], 26, v140
    v_cmp_le_i32 s[62:63], 27, v140
    v_mov_b32 v80, 0
    v_mov_b32 v81, 0
    v_mov_b32 v82, 0
    v_mov_b32 v83, 0
    v_mov_b32 v84, 0
    v_mov_b32 v85, 0
    v_mov_b32 v86, 0
    v_mov_b32 v87, 0
    v_mov_b32 v88, 0
    v_mov_b32 v89, 0
    v_mov_b32 v90, 0
    v_mov_b32 v91, 0
    v_mov_b32 v92, 0
    v_mov_b32 v93, 0
    v_mov_b32 v94, 0
    v_mov_b32 v95, 0
    v_mov_b32 v96, 0
    v_mov_b32 v120, 0
    v_mov_b32 v97, 0
    v_mov_b32 v121, 0
    v_mov_b32 v98, 0
    v_mov_b32 v122, 0
    v_mov_b32 v99, 0
    v_mov_b32 v123, 0
    v_mov_b32 v72, 0
    v_mov_b32 v73, 0
    v_mov_b32 v74, 0
    v_mov_b32 v75, 0
    v_mov_b32 v76, 0
    v_mov_b32 v77, 0
    v_mov_b32 v78, 0
    v_mov_b32 v79, 0
    v_cndmask_b32 v16, v139, 0, s[32:33]
    v_cndmask_b32 v17, v139, 0, s[34:35]
    v_cndmask_b32 v18, v139, 0, s[36:37]
    v_cndmask_b32 v19, v139, 0, s[38:39]
    v_cndmask_b32 v20, v139, 0, s[40:41]
    v_cndmask_b32 v21, v139, 0, s[42:43]
    v_cndmask_b32 v22, v139, 0, s[44:45]
    v_cndmask_b32 v23, v139, 0, s[46:47]
    v_cndmask_b32 v24, v139, 0, s[48:49]
    v_cndmask_b32 v25, v139, 0, s[50:51]
    v_cndmask_b32 v26, v139, 0, s[52:53]
    v_cndmask_b32 v27, v139, 0, s[54:55]
    v_cndmask_b32 v28, v139, 0, s[56:57]
    v_cndmask_b32 v29, v139, 0, s[58:59]
    v_cndmask_b32 v30, v139, 0, s[60:61]
    v_cndmask_b32 v31, v139, 0, s[62:63]
    v_mov_b32 v168, 0
    v_mov_b32 v169, 0
    v_mov_b32 v170, 0
    v_mov_b32 v171, 0
    v_mov_b32 v172, 0x2b800000
    v_mov_b32 v173, 0x5d800000
    s_lshl_b32 s90, s18, 12
    s_add_u32 s90, s90, 131072
    s_mov_b32 s24, 65536
    s_mov_b32 s23, 0
    s_mov_b32 s67, 32768
    s_waitcnt vmcnt(0)
    s_barrier
    s_lshl_b32 s21, s18, 12
    s_add_u32 m0, s21, 32768
    s_nop 0
    buffer_load_dwordx4 v136, s[8:11], s25 offen offset:0 lds
    buffer_load_dwordx4 v136, s[8:11], s25 offen offset:1024 lds
    buffer_load_dwordx4 v136, s[8:11], s25 offen offset:2048 lds
    buffer_load_dwordx4 v136, s[8:11], s25 offen offset:3072 lds
    s_add_u32 s25, s25, 32768
    s_add_u32 s20, s68, 0
    buffer_load_dwordx4 v[128:131], v127, s[8:11], s20 offen
    buffer_load_dwordx4 v[132:135], v127, s[8:11], s20 offen offset:1024
    ds_read_b128 v[108:111], v124 offset:0
    ds_read_b128 v[112:115], v124 offset:1024
    s_waitcnt lgkmcnt(0)
    v_mfma_f32_32x32x16_bf16 v[32:47], v[108:111], v[4:7], 0
    v_mfma_f32_32x32x16_bf16 v[32:47], v[112:115], v[8:11], v[32:47]
    s_cmp_lt_u32 s2, 128
    s_cselect_b32 s92, s6, s70
    s_cselect_b32 s93, s7, s71
    s_mov_b32 s94, 2097152
    s_mov_b32 s95, 0x00020000
    s_and_b32 s20, s2, 127
    s_lshl_b32 s20, s20, 14
    s_lshl_b32 s21, s18, 11
    s_add_u32 s69, s20, s21
    ds_read_b128 v[108:111], v124 offset:4096
    ds_read_b128 v[112:115], v124 offset:5120
    ds_read_b128 v[116:119], v124 offset:2048
    s_nop 15
p2_bloop:
    s_waitcnt lgkmcnt(1)
    v_exp_f32 v32, v32
    v_exp_f32 v33, v33
    v_mfma_f32_32x32x16_bf16 v[80:95], v[120:123], v[76:79], v[80:95]
    ds_read_b128 v[120:123], v124 offset:3072
    v_exp_f32 v34, v34
    v_exp_f32 v35, v35
    v_exp_f32 v36, v36
    v_mfma_f32_32x32x16_bf16 v[48:63], v[108:111], v[4:7], 0
    ds_read_b128 v[108:111], v124 offset:8192
    v_exp_f32 v37, v37
    v_exp_f32 v38, v38
    v_exp_f32 v39, v39
    v_mfma_f32_32x32x16_bf16 v[48:63], v[112:115], v[8:11], v[48:63]
    ds_read_b128 v[112:115], v124 offset:9216
    v_cvt_pk_bf16_f32 v64, v32, v33
    v_cvt_pk_bf16_f32 v65, v34, v35
    v_cvt_pk_bf16_f32 v66, v36, v37
    v_cvt_pk_bf16_f32 v67, v38, v39
    v_exp_f32 v40, v40
    v_exp_f32 v41, v41
    s_waitcnt lgkmcnt(3)
    v_mfma_f32_32x32x16_bf16 v[80:95], v[116:119], v[64:67], v[80:95]
    ds_read_b128 v[116:119], v124 offset:6144
    v_exp_f32 v42, v42
    v_exp_f32 v43, v43
    v_smfmac_f32_16x16x64_bf16 v[96:99], v[100:103], v[72:79], v104
    v_exp_f32 v44, v44
    v_exp_f32 v45, v45
    v_exp_f32 v46, v46
    v_exp_f32 v47, v47
    v_cvt_pk_bf16_f32 v68, v40, v41
    v_cvt_pk_bf16_f32 v69, v42, v43
    v_cvt_pk_bf16_f32 v70, v44, v45
    v_cvt_pk_bf16_f32 v71, v46, v47
    s_waitcnt lgkmcnt(1)
    v_exp_f32 v48, v48
    v_exp_f32 v49, v49
    v_mfma_f32_32x32x16_bf16 v[80:95], v[120:123], v[68:71], v[80:95]
    ds_read_b128 v[120:123], v124 offset:7168
    v_exp_f32 v50, v50
    v_exp_f32 v51, v51
    v_exp_f32 v52, v52
    v_mfma_f32_32x32x16_bf16 v[32:47], v[108:111], v[4:7], 0
    ds_read_b128 v[108:111], v124 offset:12288
    v_exp_f32 v53, v53
    v_exp_f32 v54, v54
    v_exp_f32 v55, v55
    v_mfma_f32_32x32x16_bf16 v[32:47], v[112:115], v[8:11], v[32:47]
    ds_read_b128 v[112:115], v124 offset:13312
    v_cvt_pk_bf16_f32 v72, v48, v49
    v_cvt_pk_bf16_f32 v73, v50, v51
    v_cvt_pk_bf16_f32 v74, v52, v53
    v_cvt_pk_bf16_f32 v75, v54, v55
    v_exp_f32 v56, v56
    v_exp_f32 v57, v57
    s_waitcnt lgkmcnt(3)
    v_mfma_f32_32x32x16_bf16 v[80:95], v[116:119], v[72:75], v[80:95]
    ds_read_b128 v[116:119], v124 offset:10240
    v_exp_f32 v58, v58
    v_exp_f32 v59, v59
    v_smfmac_f32_16x16x64_bf16 v[96:99], v[100:103], v[64:71], v104
    v_exp_f32 v60, v60
    v_exp_f32 v61, v61
    v_exp_f32 v62, v62
    v_exp_f32 v63, v63
    v_cvt_pk_bf16_f32 v76, v56, v57
    v_cvt_pk_bf16_f32 v77, v58, v59
    v_cvt_pk_bf16_f32 v78, v60, v61
    v_cvt_pk_bf16_f32 v79, v62, v63
    s_waitcnt lgkmcnt(1)
    v_exp_f32 v32, v32
    v_exp_f32 v33, v33
    v_mfma_f32_32x32x16_bf16 v[80:95], v[120:123], v[76:79], v[80:95]
    ds_read_b128 v[120:123], v124 offset:11264
    v_exp_f32 v34, v34
    v_exp_f32 v35, v35
    v_exp_f32 v36, v36
    v_mfma_f32_32x32x16_bf16 v[48:63], v[108:111], v[4:7], 0
    ds_read_b128 v[108:111], v124 offset:16384
    v_exp_f32 v37, v37
    v_exp_f32 v38, v38
    v_exp_f32 v39, v39
    v_mfma_f32_32x32x16_bf16 v[48:63], v[112:115], v[8:11], v[48:63]
    ds_read_b128 v[112:115], v124 offset:17408
    v_cvt_pk_bf16_f32 v64, v32, v33
    v_cvt_pk_bf16_f32 v65, v34, v35
    v_cvt_pk_bf16_f32 v66, v36, v37
    v_cvt_pk_bf16_f32 v67, v38, v39
    v_exp_f32 v40, v40
    v_exp_f32 v41, v41
    s_waitcnt lgkmcnt(3)
    v_mfma_f32_32x32x16_bf16 v[80:95], v[116:119], v[64:67], v[80:95]
    ds_read_b128 v[116:119], v124 offset:14336
    v_exp_f32 v42, v42
    v_exp_f32 v43, v43
    v_smfmac_f32_16x16x64_bf16 v[96:99], v[100:103], v[72:79], v104
    v_exp_f32 v44, v44
    v_exp_f32 v45, v45
    v_exp_f32 v46, v46
    v_exp_f32 v47, v47
    v_cvt_pk_bf16_f32 v68, v40, v41
    v_cvt_pk_bf16_f32 v69, v42, v43
    v_cvt_pk_bf16_f32 v70, v44, v45
    v_cvt_pk_bf16_f32 v71, v46, v47
    s_waitcnt lgkmcnt(1)
    v_exp_f32 v48, v48
    v_exp_f32 v49, v49
    v_mfma_f32_32x32x16_bf16 v[80:95], v[120:123], v[68:71], v[80:95]
    ds_read_b128 v[120:123], v124 offset:15360
    v_exp_f32 v50, v50
    v_exp_f32 v51, v51
    v_exp_f32 v52, v52
    v_mfma_f32_32x32x16_bf16 v[32:47], v[108:111], v[4:7], 0
    ds_read_b128 v[108:111], v124 offset:20480
    v_exp_f32 v53, v53
    v_exp_f32 v54, v54
    v_exp_f32 v55, v55
    v_mfma_f32_32x32x16_bf16 v[32:47], v[112:115], v[8:11], v[32:47]
    ds_read_b128 v[112:115], v124 offset:21504
    v_cvt_pk_bf16_f32 v72, v48, v49
    v_cvt_pk_bf16_f32 v73, v50, v51
    v_cvt_pk_bf16_f32 v74, v52, v53
    v_cvt_pk_bf16_f32 v75, v54, v55
    v_exp_f32 v56, v56
    v_exp_f32 v57, v57
    s_waitcnt lgkmcnt(3)
    v_mfma_f32_32x32x16_bf16 v[80:95], v[116:119], v[72:75], v[80:95]
    ds_read_b128 v[116:119], v124 offset:18432
    v_exp_f32 v58, v58
    v_exp_f32 v59, v59
    v_smfmac_f32_16x16x64_bf16 v[96:99], v[100:103], v[64:71], v104
    v_exp_f32 v60, v60
    v_exp_f32 v61, v61
    v_exp_f32 v62, v62
    v_exp_f32 v63, v63
    v_cvt_pk_bf16_f32 v76, v56, v57
    v_cvt_pk_bf16_f32 v77, v58, v59
    v_cvt_pk_bf16_f32 v78, v60, v61
    v_cvt_pk_bf16_f32 v79, v62, v63
    s_waitcnt lgkmcnt(1)
    v_exp_f32 v32, v32
    v_exp_f32 v33, v33
    v_mfma_f32_32x32x16_bf16 v[80:95], v[120:123], v[76:79], v[80:95]
    ds_read_b128 v[120:123], v124 offset:19456
    v_exp_f32 v34, v34
    v_exp_f32 v35, v35
    v_exp_f32 v36, v36
    v_mfma_f32_32x32x16_bf16 v[48:63], v[108:111], v[4:7], 0
    ds_read_b128 v[108:111], v124 offset:24576
    v_exp_f32 v37, v37
    v_exp_f32 v38, v38
    v_exp_f32 v39, v39
    v_mfma_f32_32x32x16_bf16 v[48:63], v[112:115], v[8:11], v[48:63]
    ds_read_b128 v[112:115], v124 offset:25600
    v_cvt_pk_bf16_f32 v64, v32, v33
    v_cvt_pk_bf16_f32 v65, v34, v35
    v_cvt_pk_bf16_f32 v66, v36, v37
    v_cvt_pk_bf16_f32 v67, v38, v39
    v_exp_f32 v40, v40
    v_exp_f32 v41, v41
    s_waitcnt lgkmcnt(3)
    v_mfma_f32_32x32x16_bf16 v[80:95], v[116:119], v[64:67], v[80:95]
    ds_read_b128 v[116:119], v124 offset:22528
    v_exp_f32 v42, v42
    v_exp_f32 v43, v43
    v_smfmac_f32_16x16x64_bf16 v[96:99], v[100:103], v[72:79], v104
    v_exp_f32 v44, v44
    v_exp_f32 v45, v45
    v_exp_f32 v46, v46
    v_exp_f32 v47, v47
    v_cvt_pk_bf16_f32 v68, v40, v41
    v_cvt_pk_bf16_f32 v69, v42, v43
    v_cvt_pk_bf16_f32 v70, v44, v45
    v_cvt_pk_bf16_f32 v71, v46, v47
    s_waitcnt lgkmcnt(1)
    v_exp_f32 v48, v48
    v_exp_f32 v49, v49
    v_mfma_f32_32x32x16_bf16 v[80:95], v[120:123], v[68:71], v[80:95]
    ds_read_b128 v[120:123], v124 offset:23552
    v_exp_f32 v50, v50
    v_exp_f32 v51, v51
    v_exp_f32 v52, v52
    v_mfma_f32_32x32x16_bf16 v[32:47], v[108:111], v[4:7], 0
    ds_read_b128 v[108:111], v124 offset:28672
    v_exp_f32 v53, v53
    v_exp_f32 v54, v54
    v_exp_f32 v55, v55
    v_mfma_f32_32x32x16_bf16 v[32:47], v[112:115], v[8:11], v[32:47]
    ds_read_b128 v[112:115], v124 offset:29696
    v_cvt_pk_bf16_f32 v72, v48, v49
    v_cvt_pk_bf16_f32 v73, v50, v51
    v_cvt_pk_bf16_f32 v74, v52, v53
    v_cvt_pk_bf16_f32 v75, v54, v55
    v_exp_f32 v56, v56
    v_exp_f32 v57, v57
    s_waitcnt lgkmcnt(3)
    v_mfma_f32_32x32x16_bf16 v[80:95], v[116:119], v[72:75], v[80:95]
    ds_read_b128 v[116:119], v124 offset:26624
    v_exp_f32 v58, v58
    v_exp_f32 v59, v59
    v_smfmac_f32_16x16x64_bf16 v[96:99], v[100:103], v[64:71], v104
    v_exp_f32 v60, v60
    v_exp_f32 v61, v61
    v_exp_f32 v62, v62
    v_exp_f32 v63, v63
    v_cvt_pk_bf16_f32 v76, v56, v57
    v_cvt_pk_bf16_f32 v77, v58, v59
    v_cvt_pk_bf16_f32 v78, v60, v61
    v_cvt_pk_bf16_f32 v79, v62, v63
    s_waitcnt lgkmcnt(1)
    v_exp_f32 v32, v32
    v_exp_f32 v33, v33
    v_mfma_f32_32x32x16_bf16 v[80:95], v[120:123], v[76:79], v[80:95]
    ds_read_b128 v[120:123], v124 offset:27648
    v_exp_f32 v34, v34
    v_exp_f32 v35, v35
    v_exp_f32 v36, v36
    v_mfma_f32_32x32x16_bf16 v[48:63], v[108:111], v[4:7], 0
    s_waitcnt vmcnt(0)
    s_barrier
    s_cmp_lg_u32 s23, 6
    s_cbranch_scc1 p2_nopf_2
    buffer_load_dwordx4 v[144:147], v127, s[92:95], s69 offen offset:0
    buffer_load_dwordx4 v[148:151], v127, s[92:95], s69 offen offset:1024
p2_nopf_2:
    s_cmp_ge_u32 s23, 6
    s_cbranch_scc1 p2_nodma_1
    s_lshl_b32 s21, s18, 12
    s_add_u32 m0, s21, s24
    s_nop 0
    buffer_load_dwordx4 v136, s[8:11], s25 offen offset:0 lds
    buffer_load_dwordx4 v136, s[8:11], s25 offen offset:1024 lds
    buffer_load_dwordx4 v136, s[8:11], s25 offen offset:2048 lds
    buffer_load_dwordx4 v136, s[8:11], s25 offen offset:3072 lds
    s_add_u32 s25, s25, 32768
    s_add_u32 s24, s24, 32768
    s_cmp_eq_u32 s24, 98304
    s_cselect_b32 s24, 0, s24
    s_cmp_ge_u32 s23, 2
    s_cbranch_scc1 p2_nodma_1
    s_lshl_b32 s21, s18, 13
    s_add_u32 s21, s21, 98304
    s_cmp_eq_u32 s23, 1
    s_cbranch_scc1 p2_a2_3
    s_mov_b32 m0, s21
    s_nop 0
    buffer_load_dwordx4 v137, s[12:15], 0 offen offset:0 lds
    buffer_load_dwordx4 v137, s[12:15], 0 offen offset:1024 lds
    buffer_load_dwordx4 v137, s[12:15], 0 offen offset:2048 lds
    buffer_load_dwordx4 v137, s[12:15], 0 offen offset:3072 lds
    s_branch p2_nodma_1
p2_a2_3:
    s_add_u32 m0, s21, 4096
    s_nop 0
    buffer_load_dwordx4 v138, s[12:15], 0 offen offset:0 lds
    buffer_load_dwordx4 v138, s[12:15], 0 offen offset:1024 lds
    buffer_load_dwordx4 v138, s[12:15], 0 offen offset:2048 lds
    buffer_load_dwordx4 v138, s[12:15], 0 offen offset:3072 lds
p2_nodma_1:
    ds_read_b128 v[108:111], v125 offset:0
    v_exp_f32 v37, v37
    v_exp_f32 v38, v38
    v_exp_f32 v39, v39
    v_mfma_f32_32x32x16_bf16 v[48:63], v[112:115], v[8:11], v[48:63]
    ds_read_b128 v[112:115], v125 offset:1024
    v_cvt_pk_bf16_f32 v64, v32, v33
    v_cvt_pk_bf16_f32 v65, v34, v35
    v_cvt_pk_bf16_f32 v66, v36, v37
    v_cvt_pk_bf16_f32 v67, v38, v39
    v_exp_f32 v40, v40
    v_exp_f32 v41, v41
    s_waitcnt lgkmcnt(3)
    v_mfma_f32_32x32x16_bf16 v[80:95], v[116:119], v[64:67], v[80:95]
    ds_read_b128 v[116:119], v124 offset:30720
    v_exp_f32 v42, v42
    v_exp_f32 v43, v43
    v_smfmac_f32_16x16x64_bf16 v[96:99], v[100:103], v[72:79], v104
    v_exp_f32 v44, v44
    v_exp_f32 v45, v45
    v_exp_f32 v46, v46
    v_exp_f32 v47, v47
    v_cvt_pk_bf16_f32 v68, v40, v41
    v_cvt_pk_bf16_f32 v69, v42, v43
    v_cvt_pk_bf16_f32 v70, v44, v45
    v_cvt_pk_bf16_f32 v71, v46, v47
    s_cmp_eq_u32 s23, 7
    s_cbranch_scc1 p2_last
    s_waitcnt lgkmcnt(1)
    v_exp_f32 v48, v48
    v_exp_f32 v49, v49
    v_mfma_f32_32x32x16_bf16 v[80:95], v[120:123], v[68:71], v[80:95]
    ds_read_b128 v[120:123], v124 offset:31744
    v_exp_f32 v50, v50
    v_exp_f32 v51, v51
    v_exp_f32 v52, v52
    v_mfma_f32_32x32x16_bf16 v[32:47], v[108:111], v[4:7], 0
    ds_read_b128 v[108:111], v125 offset:4096
    v_exp_f32 v53, v53
    v_exp_f32 v54, v54
    v_exp_f32 v55, v55
    v_mfma_f32_32x32x16_bf16 v[32:47], v[112:115], v[8:11], v[32:47]
    ds_read_b128 v[112:115], v125 offset:5120
    v_cvt_pk_bf16_f32 v72, v48, v49
    v_cvt_pk_bf16_f32 v73, v50, v51
    v_cvt_pk_bf16_f32 v74, v52, v53
    v_cvt_pk_bf16_f32 v75, v54, v55
    v_exp_f32 v56, v56
    v_exp_f32 v57, v57
    s_waitcnt lgkmcnt(3)
    v_mfma_f32_32x32x16_bf16 v[80:95], v[116:119], v[72:75], v[80:95]
    ds_read_b128 v[116:119], v125 offset:2048
    v_exp_f32 v58, v58
    v_exp_f32 v59, v59
    v_smfmac_f32_16x16x64_bf16 v[96:99], v[100:103], v[64:71], v104
    v_exp_f32 v60, v60
    v_exp_f32 v61, v61
    v_exp_f32 v62, v62
    v_exp_f32 v63, v63
    v_cvt_pk_bf16_f32 v76, v56, v57
    v_cvt_pk_bf16_f32 v77, v58, v59
    v_cvt_pk_bf16_f32 v78, v60, v61
    v_cvt_pk_bf16_f32 v79, v62, v63
    v_mov_b32 v124, v125
    s_add_u32 s67, s67, 32768
    s_cmp_eq_u32 s67, 98304
    s_cselect_b32 s67, 0, s67
    s_add_u32 s23, s23, 1
    s_cmp_eq_u32 s23, 7
    s_cselect_b32 s20, s90, s67
    v_add_u32 v125, s20, v127
    s_branch p2_bloop
p2_last:
    s_waitcnt lgkmcnt(1)
    v_exp_f32 v48, v48
    v_exp_f32 v49, v49
    v_mfma_f32_32x32x16_bf16 v[80:95], v[120:123], v[68:71], v[80:95]
    ds_read_b128 v[120:123], v124 offset:31744
    v_exp_f32 v50, v50
    v_exp_f32 v51, v51
    v_exp_f32 v52, v52
    v_mfma_f32_32x32x16_bf16 v[32:47], v[108:111], v[128:131], v[16:31]
    ds_read_b128 v[108:111], v126 offset:28672
    v_exp_f32 v53, v53
    v_exp_f32 v54, v54
    v_exp_f32 v55, v55
    v_mfma_f32_32x32x16_bf16 v[32:47], v[112:115], v[132:135], v[32:47]
    ds_read_b128 v[112:115], v126 offset:29696
    v_cvt_pk_bf16_f32 v72, v48, v49
    v_cvt_pk_bf16_f32 v73, v50, v51
    v_cvt_pk_bf16_f32 v74, v52, v53
    v_cvt_pk_bf16_f32 v75, v54, v55
    v_exp_f32 v56, v56
    v_exp_f32 v57, v57
    s_waitcnt lgkmcnt(3)
    v_mfma_f32_32x32x16_bf16 v[80:95], v[116:119], v[72:75], v[80:95]
    ds_read_b128 v[116:119], v126 offset:34816
    v_exp_f32 v58, v58
    v_exp_f32 v59, v59
    v_smfmac_f32_16x16x64_bf16 v[96:99], v[100:103], v[64:71], v104
    v_exp_f32 v60, v60
    v_exp_f32 v61, v61
    v_exp_f32 v62, v62
    v_exp_f32 v63, v63
    v_cvt_pk_bf16_f32 v76, v56, v57
    v_cvt_pk_bf16_f32 v77, v58, v59
    v_cvt_pk_bf16_f32 v78, v60, v61
    v_cvt_pk_bf16_f32 v79, v62, v63
    s_setprio 3
    s_waitcnt lgkmcnt(1)
    v_exp_f32 v32, v32
    v_exp_f32 v33, v33
    v_mfma_f32_32x32x16_bf16 v[80:95], v[120:123], v[76:79], v[80:95]
    ds_read_b128 v[120:123], v126 offset:35840
    v_exp_f32 v34, v34
    v_exp_f32 v35, v35
    v_exp_f32 v36, v36
    s_cmp_ge_u32 s19, 1
    s_cbranch_scc0 p2_inv_4
    v_mfma_f32_32x32x16_bf16 v[48:63], v[108:111], v[128:131], 0
p2_back_5:
    ds_read_b128 v[108:111], v126 offset:24576
    v_exp_f32 v37, v37
    v_exp_f32 v38, v38
    v_exp_f32 v39, v39
    v_mfma_f32_32x32x16_bf16 v[48:63], v[112:115], v[132:135], v[48:63]
    ds_read_b128 v[112:115], v126 offset:25600
    v_cvt_pk_bf16_f32 v64, v32, v33
    v_cvt_pk_bf16_f32 v65, v34, v35
    v_cvt_pk_bf16_f32 v66, v36, v37
    v_cvt_pk_bf16_f32 v67, v38, v39
    v_exp_f32 v40, v40
    v_exp_f32 v41, v41
    s_waitcnt lgkmcnt(3)
    v_mfma_f32_32x32x16_bf16 v[152:167], v[116:119], v[64:67], 0
    ds_read_b128 v[116:119], v126 offset:30720
    v_exp_f32 v42, v42
    v_exp_f32 v43, v43
    v_smfmac_f32_16x16x64_bf16 v[96:99], v[100:103], v[72:79], v104
    v_exp_f32 v44, v44
    v_exp_f32 v45, v45
    v_exp_f32 v46, v46
    v_exp_f32 v47, v47
    v_cvt_pk_bf16_f32 v68, v40, v41
    v_cvt_pk_bf16_f32 v69, v42, v43
    v_cvt_pk_bf16_f32 v70, v44, v45
    v_cvt_pk_bf16_f32 v71, v46, v47
    s_setprio 3
    s_waitcnt lgkmcnt(1)
    v_exp_f32 v48, v48
    v_exp_f32 v49, v49
    v_mfma_f32_32x32x16_bf16 v[152:167], v[120:123], v[68:71], v[152:167]
    ds_read_b128 v[120:123], v126 offset:31744
    v_exp_f32 v50, v50
    v_exp_f32 v51, v51
    v_exp_f32 v52, v52
    s_cmp_ge_u32 s19, 2
    s_cbranch_scc0 p2_inv_6
    v_mfma_f32_32x32x16_bf16 v[32:47], v[108:111], v[128:131], 0
p2_back_7:
    v_add_f32 v140, v96, v97
    v_rcp_f32 v141, v140
    v_med3_f32 v142, v140, v172, v173
    v_cmp_neq_f32 vcc, v140, v142
    v_mul_f32 v80, v80, v141
    v_mul_f32 v81, v81, v141
    v_mul_f32 v82, v82, v141
    v_mul_f32 v83, v83, v141
    v_mul_f32 v84, v84, v141
    v_mul_f32 v85, v85, v141
    s_mov_b64 s[96:97], vcc
    ds_read_b128 v[108:111], v126 offset:20480
    v_exp_f32 v53, v53
    v_exp_f32 v54, v54
    v_exp_f32 v55, v55
    v_mfma_f32_32x32x16_bf16 v[32:47], v[112:115], v[132:135], v[32:47]
    v_mul_f32 v86, v86, v141
    v_mul_f32 v87, v87, v141
    v_mul_f32 v88, v88, v141
    v_mul_f32 v89, v89, v141
    v_mul_f32 v90, v90, v141
    v_mul_f32 v91, v91, v141
    v_mul_f32 v92, v92, v141
    v_mul_f32 v93, v93, v141
    v_mul_f32 v94, v94, v141
    v_mul_f32 v95, v95, v141
    ds_read_b128 v[112:115], v126 offset:21504
    v_cvt_pk_bf16_f32 v72, v48, v49
    v_cvt_pk_bf16_f32 v73, v50, v51
    v_cvt_pk_bf16_f32 v74, v52, v53
    v_cvt_pk_bf16_f32 v75, v54, v55
    v_exp_f32 v56, v56
    v_exp_f32 v57, v57
    s_waitcnt lgkmcnt(3)
    v_mfma_f32_32x32x16_bf16 v[152:167], v[116:119], v[72:75], v[152:167]
    v_cvt_pk_bf16_f32 v80, v80, v81
    v_cvt_pk_bf16_f32 v81, v82, v83
    v_cvt_pk_bf16_f32 v82, v84, v85
    v_cvt_pk_bf16_f32 v83, v86, v87
    v_cvt_pk_bf16_f32 v88, v88, v89
    v_cvt_pk_bf16_f32 v89, v90, v91
    v_cvt_pk_bf16_f32 v90, v92, v93
    v_cvt_pk_bf16_f32 v91, v94, v95
    s_lshl_b32 s20, s19, 16
    s_lshl_b32 s21, s16, 11
    s_add_u32 s20, s20, s21
    s_add_u32 s20, s20, 22020096
    s_cbranch_vccnz p2_nost_8
    buffer_store_dwordx4 v[80:83], v127, s[8:11], s20 offen offset:0 sc1
    buffer_store_dwordx4 v[88:91], v127, s[8:11], s20 offen offset:1024 sc1
p2_nost_8:
    ds_read_b128 v[116:119], v126 offset:26624
    v_exp_f32 v58, v58
    v_exp_f32 v59, v59
    v_smfmac_f32_16x16x64_bf16 v[168:171], v[100:103], v[64:71], v104
    v_exp_f32 v60, v60
    v_exp_f32 v61, v61
    v_exp_f32 v62, v62
    v_exp_f32 v63, v63
    v_cvt_pk_bf16_f32 v76, v56, v57
    v_cvt_pk_bf16_f32 v77, v58, v59
    v_cvt_pk_bf16_f32 v78, v60, v61
    v_cvt_pk_bf16_f32 v79, v62, v63
    s_setprio 2
    s_waitcnt lgkmcnt(1)
    v_exp_f32 v32, v32
    v_exp_f32 v33, v33
    v_mfma_f32_32x32x16_bf16 v[152:167], v[120:123], v[76:79], v[152:167]
    ds_read_b128 v[120:123], v126 offset:27648
    v_exp_f32 v34, v34
    v_exp_f32 v35, v35
    v_exp_f32 v36, v36
    s_cmp_ge_u32 s19, 3
    s_cbranch_scc0 p2_inv_9
    v_mfma_f32_32x32x16_bf16 v[48:63], v[108:111], v[128:131], 0
p2_back_10:
    ds_read_b128 v[108:111], v126 offset:16384
    v_exp_f32 v37, v37
    v_exp_f32 v38, v38
    v_exp_f32 v39, v39
    v_mfma_f32_32x32x16_bf16 v[48:63], v[112:115], v[132:135], v[48:63]
    ds_read_b128 v[112:115], v126 offset:17408
    v_cvt_pk_bf16_f32 v64, v32, v33
    v_cvt_pk_bf16_f32 v65, v34, v35
    v_cvt_pk_bf16_f32 v66, v36, v37
    v_cvt_pk_bf16_f32 v67, v38, v39
    v_exp_f32 v40, v40
    v_exp_f32 v41, v41
    s_waitcnt lgkmcnt(3)
    v_mfma_f32_32x32x16_bf16 v[152:167], v[116:119], v[64:67], v[152:167]
    ds_read_b128 v[116:119], v126 offset:22528
    v_exp_f32 v42, v42
    v_exp_f32 v43, v43
    v_smfmac_f32_16x16x64_bf16 v[168:171], v[100:103], v[72:79], v104
    v_exp_f32 v44, v44
    v_exp_f32 v45, v45
    v_exp_f32 v46, v46
    v_exp_f32 v47, v47
    v_cvt_pk_bf16_f32 v68, v40, v41
    v_cvt_pk_bf16_f32 v69, v42, v43
    v_cvt_pk_bf16_f32 v70, v44, v45
    v_cvt_pk_bf16_f32 v71, v46, v47
    s_setprio 2
    s_waitcnt lgkmcnt(1)
    v_exp_f32 v48, v48
    v_exp_f32 v49, v49
    v_mfma_f32_32x32x16_bf16 v[152:167], v[120:123], v[68:71], v[152:167]
    ds_read_b128 v[120:123], v126 offset:23552
    v_exp_f32 v50, v50
    v_exp_f32 v51, v51
    v_exp_f32 v52, v52
    s_cmp_ge_u32 s19, 4
    s_cbranch_scc0 p2_inv_11
    v_mfma_f32_32x32x16_bf16 v[32:47], v[108:111], v[128:131], 0
p2_back_12:
    ds_read_b128 v[108:111], v126 offset:12288
    v_exp_f32 v53, v53
    v_exp_f32 v54, v54
    v_exp_f32 v55, v55
    v_mfma_f32_32x32x16_bf16 v[32:47], v[112:115], v[132:135], v[32:47]
    ds_read_b128 v[112:115], v126 offset:13312
    v_cvt_pk_bf16_f32 v72, v48, v49
    v_cvt_pk_bf16_f32 v73, v50, v51
    v_cvt_pk_bf16_f32 v74, v52, v53
    v_cvt_pk_bf16_f32 v75, v54, v55
    v_exp_f32 v56, v56
    v_exp_f32 v57, v57
    s_waitcnt lgkmcnt(3)
    v_mfma_f32_32x32x16_bf16 v[152:167], v[116:119], v[72:75], v[152:167]
    ds_read_b128 v[116:119], v126 offset:18432
    v_exp_f32 v58, v58
    v_exp_f32 v59, v59
    v_smfmac_f32_16x16x64_bf16 v[168:171], v[100:103], v[64:71], v104
    v_exp_f32 v60, v60
    v_exp_f32 v61, v61
    v_exp_f32 v62, v62
    v_exp_f32 v63, v63
    v_cvt_pk_bf16_f32 v76, v56, v57
    v_cvt_pk_bf16_f32 v77, v58, v59
    v_cvt_pk_bf16_f32 v78, v60, v61
    v_cvt_pk_bf16_f32 v79, v62, v63
    s_setprio 1
    s_waitcnt lgkmcnt(1)
    v_exp_f32 v32, v32
    v_exp_f32 v33, v33
    v_mfma_f32_32x32x16_bf16 v[152:167], v[120:123], v[76:79], v[152:167]
    ds_read_b128 v[120:123], v126 offset:19456
    v_exp_f32 v34, v34
    v_exp_f32 v35, v35
    v_exp_f32 v36, v36
    s_cmp_ge_u32 s19, 5
    s_cbranch_scc0 p2_inv_13
    v_mfma_f32_32x32x16_bf16 v[48:63], v[108:111], v[128:131], 0
p2_back_14:
    ds_read_b128 v[108:111], v126 offset:8192
    v_exp_f32 v37, v37
    v_exp_f32 v38, v38
    v_exp_f32 v39, v39
    v_mfma_f32_32x32x16_bf16 v[48:63], v[112:115], v[132:135], v[48:63]
    ds_read_b128 v[112:115], v126 offset:9216
    v_cvt_pk_bf16_f32 v64, v32, v33
    v_cvt_pk_bf16_f32 v65, v34, v35
    v_cvt_pk_bf16_f32 v66, v36, v37
    v_cvt_pk_bf16_f32 v67, v38, v39
    v_exp_f32 v40, v40
    v_exp_f32 v41, v41
    s_waitcnt lgkmcnt(3)
    v_mfma_f32_32x32x16_bf16 v[152:167], v[116:119], v[64:67], v[152:167]
    ds_read_b128 v[116:119], v126 offset:14336
    v_exp_f32 v42, v42
    v_exp_f32 v43, v43
    v_smfmac_f32_16x16x64_bf16 v[168:171], v[100:103], v[72:79], v104
    v_exp_f32 v44, v44
    v_exp_f32 v45, v45
    v_exp_f32 v46, v46
    v_exp_f32 v47, v47
    v_cvt_pk_bf16_f32 v68, v40, v41
    v_cvt_pk_bf16_f32 v69, v42, v43
    v_cvt_pk_bf16_f32 v70, v44, v45
    v_cvt_pk_bf16_f32 v71, v46, v47
    s_setprio 1
    s_waitcnt lgkmcnt(1)
    v_exp_f32 v48, v48
    v_exp_f32 v49, v49
    v_mfma_f32_32x32x16_bf16 v[152:167], v[120:123], v[68:71], v[152:167]
    ds_read_b128 v[120:123], v126 offset:15360
    v_exp_f32 v50, v50
    v_exp_f32 v51, v51
    v_exp_f32 v52, v52
    s_cmp_ge_u32 s19, 6
    s_cbranch_scc0 p2_inv_15
    v_mfma_f32_32x32x16_bf16 v[32:47], v[108:111], v[128:131], 0
p2_back_16:
    ds_read_b128 v[108:111], v126 offset:4096
    v_exp_f32 v53, v53
    v_exp_f32 v54, v54
    v_exp_f32 v55, v55
    v_mfma_f32_32x32x16_bf16 v[32:47], v[112:115], v[132:135], v[32:47]
    ds_read_b128 v[112:115], v126 offset:5120
    v_cvt_pk_bf16_f32 v72, v48, v49
    v_cvt_pk_bf16_f32 v73, v50, v51
    v_cvt_pk_bf16_f32 v74, v52, v53
    v_cvt_pk_bf16_f32 v75, v54, v55
    v_exp_f32 v56, v56
    v_exp_f32 v57, v57
    s_waitcnt lgkmcnt(3)
    v_mfma_f32_32x32x16_bf16 v[152:167], v[116:119], v[72:75], v[152:167]
    ds_read_b128 v[116:119], v126 offset:10240
    v_exp_f32 v58, v58
    v_exp_f32 v59, v59
    v_smfmac_f32_16x16x64_bf16 v[168:171], v[100:103], v[64:71], v104
    v_exp_f32 v60, v60
    v_exp_f32 v61, v61
    v_exp_f32 v62, v62
    v_exp_f32 v63, v63
    v_cvt_pk_bf16_f32 v76, v56, v57
    v_cvt_pk_bf16_f32 v77, v58, v59
    v_cvt_pk_bf16_f32 v78, v60, v61
    v_cvt_pk_bf16_f32 v79, v62, v63
    s_setprio 0
    s_waitcnt lgkmcnt(1)
    v_exp_f32 v32, v32
    v_exp_f32 v33, v33
    v_mfma_f32_32x32x16_bf16 v[152:167], v[120:123], v[76:79], v[152:167]
    ds_read_b128 v[120:123], v126 offset:11264
    v_exp_f32 v34, v34
    v_exp_f32 v35, v35
    v_exp_f32 v36, v36
    s_cmp_ge_u32 s19, 7
    s_cbranch_scc0 p2_inv_17
    v_mfma_f32_32x32x16_bf16 v[48:63], v[108:111], v[128:131], 0
p2_back_18:
    ds_read_b128 v[108:111], v126 offset:0
    v_exp_f32 v37, v37
    v_exp_f32 v38, v38
    v_exp_f32 v39, v39
    v_mfma_f32_32x32x16_bf16 v[48:63], v[112:115], v[132:135], v[48:63]
    ds_read_b128 v[112:115], v126 offset:1024
    v_cvt_pk_bf16_f32 v64, v32, v33
    v_cvt_pk_bf16_f32 v65, v34, v35
    v_cvt_pk_bf16_f32 v66, v36, v37
    v_cvt_pk_bf16_f32 v67, v38, v39
    v_exp_f32 v40, v40
    v_exp_f32 v41, v41
    s_waitcnt lgkmcnt(3)
    v_mfma_f32_32x32x16_bf16 v[152:167], v[116:119], v[64:67], v[152:167]
    ds_read_b128 v[116:119], v126 offset:6144
    v_exp_f32 v42, v42
    v_exp_f32 v43, v43
    v_smfmac_f32_16x16x64_bf16 v[168:171], v[100:103], v[72:79], v104
    v_exp_f32 v44, v44
    v_exp_f32 v45, v45
    v_exp_f32 v46, v46
    v_exp_f32 v47, v47
    v_cvt_pk_bf16_f32 v68, v40, v41
    v_cvt_pk_bf16_f32 v69, v42, v43
    v_cvt_pk_bf16_f32 v70, v44, v45
    v_cvt_pk_bf16_f32 v71, v46, v47
    s_setprio 0
    s_waitcnt lgkmcnt(1)
    v_exp_f32 v48, v48
    v_exp_f32 v49, v49
    v_mfma_f32_32x32x16_bf16 v[152:167], v[120:123], v[68:71], v[152:167]
    ds_read_b128 v[120:123], v126 offset:7168
    v_exp_f32 v50, v50
    v_exp_f32 v51, v51
    v_exp_f32 v52, v52
    s_cmp_ge_u32 s19, 8
    s_cbranch_scc0 p2_inv_19
    v_cndmask_b32 v16, 0, v139, s[32:33]
    v_cndmask_b32 v17, 0, v139, s[34:35]
    v_cndmask_b32 v18, 0, v139, s[36:37]
    v_cndmask_b32 v19, 0, v139, s[38:39]
    v_cndmask_b32 v20, 0, v139, s[40:41]
    v_cndmask_b32 v21, 0, v139, s[42:43]
    v_cndmask_b32 v22, 0, v139, s[44:45]
    v_cndmask_b32 v23, 0, v139, s[46:47]
    v_cndmask_b32 v24, 0, v139, s[48:49]
    v_cndmask_b32 v25, 0, v139, s[50:51]
    v_cndmask_b32 v26, 0, v139, s[52:53]
    v_cndmask_b32 v27, 0, v139, s[54:55]
    v_cndmask_b32 v28, 0, v139, s[56:57]
    v_cndmask_b32 v29, 0, v139, s[58:59]
    v_cndmask_b32 v30, 0, v139, s[60:61]
    v_cndmask_b32 v31, 0, v139, s[62:63]
p2_back_20:
    s_nop 1
    v_mfma_f32_32x32x16_bf16 v[32:47], v[108:111], v[128:131], v[16:31]
    v_exp_f32 v53, v53
    v_exp_f32 v54, v54
    v_exp_f32 v55, v55
    v_mfma_f32_32x32x16_bf16 v[32:47], v[112:115], v[132:135], v[32:47]
    v_cvt_pk_bf16_f32 v72, v48, v49
    v_cvt_pk_bf16_f32 v73, v50, v51
    v_cvt_pk_bf16_f32 v74, v52, v53
    v_cvt_pk_bf16_f32 v75, v54, v55
    v_exp_f32 v56, v56
    v_exp_f32 v57, v57
    s_waitcnt lgkmcnt(1)
    v_mfma_f32_32x32x16_bf16 v[152:167], v[116:119], v[72:75], v[152:167]
    ds_read_b128 v[116:119], v126 offset:2048
    v_exp_f32 v58, v58
    v_exp_f32 v59, v59
    v_smfmac_f32_16x16x64_bf16 v[168:171], v[100:103], v[64:71], v104
    v_exp_f32 v60, v60
    v_exp_f32 v61, v61
    v_exp_f32 v62, v62
    v_exp_f32 v63, v63
    v_cvt_pk_bf16_f32 v76, v56, v57
    v_cvt_pk_bf16_f32 v77, v58, v59
    v_cvt_pk_bf16_f32 v78, v60, v61
    v_cvt_pk_bf16_f32 v79, v62, v63
    s_setprio 0
    s_waitcnt lgkmcnt(1)
    v_exp_f32 v32, v32
    v_exp_f32 v33, v33
    v_mfma_f32_32x32x16_bf16 v[152:167], v[120:123], v[76:79], v[152:167]
    ds_read_b128 v[120:123], v126 offset:3072
    v_exp_f32 v34, v34
    v_exp_f32 v35, v35
    v_exp_f32 v36, v36
    v_exp_f32 v37, v37
    v_exp_f32 v38, v38
    v_exp_f32 v39, v39
    v_cvt_pk_bf16_f32 v64, v32, v33
    v_cvt_pk_bf16_f32 v65, v34, v35
    v_cvt_pk_bf16_f32 v66, v36, v37
    v_cvt_pk_bf16_f32 v67, v38, v39
    v_exp_f32 v40, v40
    v_exp_f32 v41, v41
    s_waitcnt lgkmcnt(1)
    v_mfma_f32_32x32x16_bf16 v[152:167], v[116:119], v[64:67], v[152:167]
    v_exp_f32 v42, v42
    v_exp_f32 v43, v43
    v_smfmac_f32_16x16x64_bf16 v[168:171], v[100:103], v[72:79], v104
    v_exp_f32 v44, v44
    v_exp_f32 v45, v45
    v_exp_f32 v46, v46
    v_exp_f32 v47, v47
    v_cvt_pk_bf16_f32 v68, v40, v41
    v_cvt_pk_bf16_f32 v69, v42, v43
    v_cvt_pk_bf16_f32 v70, v44, v45
    v_cvt_pk_bf16_f32 v71, v46, v47
    s_waitcnt lgkmcnt(0)
    s_nop 0
    v_mfma_f32_32x32x16_bf16 v[152:167], v[120:123], v[68:71], v[152:167]
    v_smfmac_f32_16x16x64_bf16 v[168:171], v[100:103], v[64:71], v104
    s_nop 11
    v_add_f32 v140, v168, v169
    v_med3_f32 v142, v140, v172, v173
    v_cmp_neq_f32 vcc, v140, v142
    s_nop 1
    s_cbranch_vccnz p2_slow_A
p2_norm_A:
    v_rcp_f32 v141, v140
    s_nop 0
    v_mul_f32 v152, v152, v141
    v_mul_f32 v153, v153, v141
    v_mul_f32 v154, v154, v141
    v_mul_f32 v155, v155, v141
    v_mul_f32 v156, v156, v141
    v_mul_f32 v157, v157, v141
    v_mul_f32 v158, v158, v141
    v_mul_f32 v159, v159, v141
    v_mul_f32 v160, v160, v141
    v_mul_f32 v161, v161, v141
    v_mul_f32 v162, v162, v141
    v_mul_f32 v163, v163, v141
    v_mul_f32 v164, v164, v141
    v_mul_f32 v165, v165, v141
    v_mul_f32 v166, v166, v141
    v_mul_f32 v167, v167, v141
    v_cvt_pk_bf16_f32 v152, v152, v153
    v_cvt_pk_bf16_f32 v153, v154, v155
    v_cvt_pk_bf16_f32 v154, v156, v157
    v_cvt_pk_bf16_f32 v155, v158, v159
    v_cvt_pk_bf16_f32 v160, v160, v161
    v_cvt_pk_bf16_f32 v161, v162, v163
    v_cvt_pk_bf16_f32 v162, v164, v165
    v_cvt_pk_bf16_f32 v163, v166, v167
    s_lshl_b32 s20, s19, 16
    s_lshl_b32 s21, s16, 11
    s_add_u32 s20, s20, s21
    s_add_u32 s20, s20, 17825792
    buffer_store_dwordx4 v[152:155], v127, s[8:11], s20 offen offset:0 sc1
    buffer_store_dwordx4 v[160:163], v127, s[8:11], s20 offen offset:1024 sc1
    s_cmp_lg_u64 s[96:97], 0
    s_cbranch_scc1 p2_slow_B
p2_done:
    s_endpgm
p2_inv_4:
    v_mov_b32 v16, v139
    v_mov_b32 v17, v139
    v_mov_b32 v18, v139
    v_mov_b32 v19, v139
    v_mov_b32 v20, v139
    v_mov_b32 v21, v139
    v_mov_b32 v22, v139
    v_mov_b32 v23, v139
    v_mov_b32 v24, v139
    v_mov_b32 v25, v139
    v_mov_b32 v26, v139
    v_mov_b32 v27, v139
    v_mov_b32 v28, v139
    v_mov_b32 v29, v139
    v_mov_b32 v30, v139
    v_mov_b32 v31, v139
    s_nop 1
    v_mfma_f32_32x32x16_bf16 v[48:63], v[108:111], v[128:131], v[16:31]
    s_branch p2_back_5
p2_inv_6:
    v_mov_b32 v16, v139
    v_mov_b32 v17, v139
    v_mov_b32 v18, v139
    v_mov_b32 v19, v139
    v_mov_b32 v20, v139
    v_mov_b32 v21, v139
    v_mov_b32 v22, v139
    v_mov_b32 v23, v139
    v_mov_b32 v24, v139
    v_mov_b32 v25, v139
    v_mov_b32 v26, v139
    v_mov_b32 v27, v139
    v_mov_b32 v28, v139
    v_mov_b32 v29, v139
    v_mov_b32 v30, v139
    v_mov_b32 v31, v139
    s_nop 1
    v_mfma_f32_32x32x16_bf16 v[32:47], v[108:111], v[128:131], v[16:31]
    s_branch p2_back_7
p2_inv_9:
    v_mov_b32 v16, v139
    v_mov_b32 v17, v139
    v_mov_b32 v18, v139
    v_mov_b32 v19, v139
    v_mov_b32 v20, v139
    v_mov_b32 v21, v139
    v_mov_b32 v22, v139
    v_mov_b32 v23, v139
    v_mov_b32 v24, v139
    v_mov_b32 v25, v139
    v_mov_b32 v26, v139
    v_mov_b32 v27, v139
    v_mov_b32 v28, v139
    v_mov_b32 v29, v139
    v_mov_b32 v30, v139
    v_mov_b32 v31, v139
    s_nop 1
    v_mfma_f32_32x32x16_bf16 v[48:63], v[108:111], v[128:131], v[16:31]
    s_branch p2_back_10
p2_inv_11:
    v_mov_b32 v16, v139
    v_mov_b32 v17, v139
    v_mov_b32 v18, v139
    v_mov_b32 v19, v139
    v_mov_b32 v20, v139
    v_mov_b32 v21, v139
    v_mov_b32 v22, v139
    v_mov_b32 v23, v139
    v_mov_b32 v24, v139
    v_mov_b32 v25, v139
    v_mov_b32 v26, v139
    v_mov_b32 v27, v139
    v_mov_b32 v28, v139
    v_mov_b32 v29, v139
    v_mov_b32 v30, v139
    v_mov_b32 v31, v139
    s_nop 1
    v_mfma_f32_32x32x16_bf16 v[32:47], v[108:111], v[128:131], v[16:31]
    s_branch p2_back_12
p2_inv_13:
    v_mov_b32 v16, v139
    v_mov_b32 v17, v139
    v_mov_b32 v18, v139
    v_mov_b32 v19, v139
    v_mov_b32 v20, v139
    v_mov_b32 v21, v139
    v_mov_b32 v22, v139
    v_mov_b32 v23, v139
    v_mov_b32 v24, v139
    v_mov_b32 v25, v139
    v_mov_b32 v26, v139
    v_mov_b32 v27, v139
    v_mov_b32 v28, v139
    v_mov_b32 v29, v139
    v_mov_b32 v30, v139
    v_mov_b32 v31, v139
    s_nop 1
    v_mfma_f32_32x32x16_bf16 v[48:63], v[108:111], v[128:131], v[16:31]
    s_branch p2_back_14
p2_inv_15:
    v_mov_b32 v16, v139
    v_mov_b32 v17, v139
    v_mov_b32 v18, v139
    v_mov_b32 v19, v139
    v_mov_b32 v20, v139
    v_mov_b32 v21, v139
    v_mov_b32 v22, v139
    v_mov_b32 v23, v139
    v_mov_b32 v24, v139
    v_mov_b32 v25, v139
    v_mov_b32 v26, v139
    v_mov_b32 v27, v139
    v_mov_b32 v28, v139
    v_mov_b32 v29, v139
    v_mov_b32 v30, v139
    v_mov_b32 v31, v139
    s_nop 1
    v_mfma_f32_32x32x16_bf16 v[32:47], v[108:111], v[128:131], v[16:31]
    s_branch p2_back_16
p2_inv_17:
    v_mov_b32 v16, v139
    v_mov_b32 v17, v139
    v_mov_b32 v18, v139
    v_mov_b32 v19, v139
    v_mov_b32 v20, v139
    v_mov_b32 v21, v139
    v_mov_b32 v22, v139
    v_mov_b32 v23, v139
    v_mov_b32 v24, v139
    v_mov_b32 v25, v139
    v_mov_b32 v26, v139
    v_mov_b32 v27, v139
    v_mov_b32 v28, v139
    v_mov_b32 v29, v139
    v_mov_b32 v30, v139
    v_mov_b32 v31, v139
    s_nop 1
    v_mfma_f32_32x32x16_bf16 v[48:63], v[108:111], v[128:131], v[16:31]
    s_branch p2_back_18
p2_inv_19:
    v_mov_b32 v16, v139
    v_mov_b32 v17, v139
    v_mov_b32 v18, v139
    v_mov_b32 v19, v139
    v_mov_b32 v20, v139
    v_mov_b32 v21, v139
    v_mov_b32 v22, v139
    v_mov_b32 v23, v139
    v_mov_b32 v24, v139
    v_mov_b32 v25, v139
    v_mov_b32 v26, v139
    v_mov_b32 v27, v139
    v_mov_b32 v28, v139
    v_mov_b32 v29, v139
    v_mov_b32 v30, v139
    v_mov_b32 v31, v139
    s_branch p2_back_20
p2_slow_B:
    s_mov_b32 s26, 16777216
    s_mov_b32 s27, 4096
    s_mov_b32 s28, 64
    v_mov_b32 v143, v139
    v_mov_b32 v142, 0
    s_mov_b32 s66, 0
    s_mov_b32 s22, s26
sp_p1_21:
    buffer_load_dwordx4 v[108:111], v127, s[8:11], s22 offen
    buffer_load_dwordx4 v[112:115], v127, s[8:11], s22 offen offset:1024
    v_mov_b32 v16, v142
    v_mov_b32 v17, v142
    v_mov_b32 v18, v142
    v_mov_b32 v19, v142
    v_mov_b32 v20, v142
    v_mov_b32 v21, v142
    v_mov_b32 v22, v142
    v_mov_b32 v23, v142
    v_mov_b32 v24, v142
    v_mov_b32 v25, v142
    v_mov_b32 v26, v142
    v_mov_b32 v27, v142
    v_mov_b32 v28, v142
    v_mov_b32 v29, v142
    v_mov_b32 v30, v142
    v_mov_b32 v31, v142
    s_waitcnt vmcnt(0)
    s_nop 1
    v_mfma_f32_32x32x16_bf16 v[32:47], v[108:111], v[4:7], v[16:31]
    v_mfma_f32_32x32x16_bf16 v[32:47], v[112:115], v[8:11], v[32:47]
    s_nop 15
    v_max3_f32 v143, v143, v32, v33
    v_max3_f32 v143, v143, v34, v35
    v_max3_f32 v143, v143, v36, v37
    v_max3_f32 v143, v143, v38, v39
    v_max3_f32 v143, v143, v40, v41
    v_max3_f32 v143, v143, v42, v43
    v_max3_f32 v143, v143, v44, v45
    v_max3_f32 v143, v143, v46, v47
    s_add_u32 s22, s22, s27
    s_add_u32 s66, s66, 1
    s_cmp_lt_u32 s66, s28
    s_cbranch_scc1 sp_p1_21
    v_mov_b32 v140, v143
    v_mov_b32 v141, v140
    s_nop 1
    v_permlane32_swap_b32 v140, v141
    s_nop 1
    v_max_f32 v140, v140, v141
    v_sub_f32 v142, 0, v140
    v_mov_b32 v80, 0
    v_mov_b32 v81, 0
    v_mov_b32 v82, 0
    v_mov_b32 v83, 0
    v_mov_b32 v84, 0
    v_mov_b32 v85, 0
    v_mov_b32 v86, 0
    v_mov_b32 v87, 0
    v_mov_b32 v88, 0
    v_mov_b32 v89, 0
    v_mov_b32 v90, 0
    v_mov_b32 v91, 0
    v_mov_b32 v92, 0
    v_mov_b32 v93, 0
    v_mov_b32 v94, 0
    v_mov_b32 v95, 0
    v_mov_b32 v96, 0
    v_mov_b32 v97, 0
    v_mov_b32 v98, 0
    v_mov_b32 v99, 0
    s_mov_b32 s66, 0
    s_mov_b32 s22, s26
sp_p2_22:
    buffer_load_dwordx4 v[108:111], v127, s[8:11], s22 offen
    buffer_load_dwordx4 v[112:115], v127, s[8:11], s22 offen offset:1024
    buffer_load_dwordx4 v[116:119], v127, s[8:11], s22 offen offset:2048
    buffer_load_dwordx4 v[120:123], v127, s[8:11], s22 offen offset:3072
    v_mov_b32 v16, v142
    v_mov_b32 v17, v142
    v_mov_b32 v18, v142
    v_mov_b32 v19, v142
    v_mov_b32 v20, v142
    v_mov_b32 v21, v142
    v_mov_b32 v22, v142
    v_mov_b32 v23, v142
    v_mov_b32 v24, v142
    v_mov_b32 v25, v142
    v_mov_b32 v26, v142
    v_mov_b32 v27, v142
    v_mov_b32 v28, v142
    v_mov_b32 v29, v142
    v_mov_b32 v30, v142
    v_mov_b32 v31, v142
    s_waitcnt vmcnt(0)
    s_nop 1
    v_mfma_f32_32x32x16_bf16 v[32:47], v[108:111], v[4:7], v[16:31]
    v_mfma_f32_32x32x16_bf16 v[32:47], v[112:115], v[8:11], v[32:47]
    s_nop 15
    v_exp_f32 v32, v32
    v_exp_f32 v33, v33
    v_exp_f32 v34, v34
    v_exp_f32 v35, v35
    v_exp_f32 v36, v36
    v_exp_f32 v37, v37
    v_exp_f32 v38, v38
    v_exp_f32 v39, v39
    v_exp_f32 v40, v40
    v_exp_f32 v41, v41
    v_exp_f32 v42, v42
    v_exp_f32 v43, v43
    v_exp_f32 v44, v44
    v_exp_f32 v45, v45
    v_exp_f32 v46, v46
    v_exp_f32 v47, v47
    s_nop 0
    v_cvt_pk_bf16_f32 v64, v32, v33
    v_cvt_pk_bf16_f32 v65, v34, v35
    v_cvt_pk_bf16_f32 v66, v36, v37
    v_cvt_pk_bf16_f32 v67, v38, v39
    v_cvt_pk_bf16_f32 v68, v40, v41
    v_cvt_pk_bf16_f32 v69, v42, v43
    v_cvt_pk_bf16_f32 v70, v44, v45
    v_cvt_pk_bf16_f32 v71, v46, v47
    s_nop 1
    v_mfma_f32_32x32x16_bf16 v[80:95], v[116:119], v[64:67], v[80:95]
    v_mfma_f32_32x32x16_bf16 v[80:95], v[120:123], v[68:71], v[80:95]
    v_smfmac_f32_16x16x64_bf16 v[96:99], v[100:103], v[64:71], v104
    s_nop 15
    s_add_u32 s22, s22, s27
    s_add_u32 s66, s66, 1
    s_cmp_lt_u32 s66, s28
    s_cbranch_scc1 sp_p2_22
    s_nop 15
    v_add_f32 v140, v96, v97
    v_rcp_f32 v141, v140
    s_nop 0
    v_mul_f32 v80, v80, v141
    v_mul_f32 v81, v81, v141
    v_mul_f32 v82, v82, v141
    v_mul_f32 v83, v83, v141
    v_mul_f32 v84, v84, v141
    v_mul_f32 v85, v85, v141
    v_mul_f32 v86, v86, v141
    v_mul_f32 v87, v87, v141
    v_mul_f32 v88, v88, v141
    v_mul_f32 v89, v89, v141
    v_mul_f32 v90, v90, v141
    v_mul_f32 v91, v91, v141
    v_mul_f32 v92, v92, v141
    v_mul_f32 v93, v93, v141
    v_mul_f32 v94, v94, v141
    v_mul_f32 v95, v95, v141
    v_cvt_pk_bf16_f32 v80, v80, v81
    v_cvt_pk_bf16_f32 v81, v82, v83
    v_cvt_pk_bf16_f32 v82, v84, v85
    v_cvt_pk_bf16_f32 v83, v86, v87
    v_cvt_pk_bf16_f32 v88, v88, v89
    v_cvt_pk_bf16_f32 v89, v90, v91
    v_cvt_pk_bf16_f32 v90, v92, v93
    v_cvt_pk_bf16_f32 v91, v94, v95
    s_lshl_b32 s20, s19, 16
    s_lshl_b32 s21, s16, 11
    s_add_u32 s20, s20, s21
    s_add_u32 s20, s20, 22020096
    buffer_store_dwordx4 v[80:83], v127, s[8:11], s20 offen offset:0 sc1
    buffer_store_dwordx4 v[88:91], v127, s[8:11], s20 offen offset:1024 sc1
    s_branch p2_done
p2_slow_A:
    s_lshl_b32 s26, s16, 18
    s_lshl_b32 s20, s19, 12
    s_add_u32 s26, s26, s20
    s_add_u32 s26, s26, 4194304
    s_mov_b32 s27, 4294963200
    s_add_u32 s28, s19, 1
    s_min_u32 s28, s28, 9
    v_mov_b32 v143, v139
    v_mov_b32 v142, 0
    s_mov_b32 s66, 0
    s_mov_b32 s22, s26
sp_p1_23:
    buffer_load_dwordx4 v[108:111], v127, s[8:11], s22 offen
    buffer_load_dwordx4 v[112:115], v127, s[8:11], s22 offen offset:1024
    s_cmp_eq_u32 s66, 0
    s_cbranch_scc1 sp_d0_24
    s_cmp_eq_u32 s66, 8
    s_cbranch_scc1 sp_d8_25
    v_mov_b32 v16, v142
    v_mov_b32 v17, v142
    v_mov_b32 v18, v142
    v_mov_b32 v19, v142
    v_mov_b32 v20, v142
    v_mov_b32 v21, v142
    v_mov_b32 v22, v142
    v_mov_b32 v23, v142
    v_mov_b32 v24, v142
    v_mov_b32 v25, v142
    v_mov_b32 v26, v142
    v_mov_b32 v27, v142
    v_mov_b32 v28, v142
    v_mov_b32 v29, v142
    v_mov_b32 v30, v142
    v_mov_b32 v31, v142
    s_branch sp_dd_26
sp_d0_24:
    v_cndmask_b32 v16, v139, v142, s[32:33]
    v_cndmask_b32 v17, v139, v142, s[34:35]
    v_cndmask_b32 v18, v139, v142, s[36:37]
    v_cndmask_b32 v19, v139, v142, s[38:39]
    v_cndmask_b32 v20, v139, v142, s[40:41]
    v_cndmask_b32 v21, v139, v142, s[42:43]
    v_cndmask_b32 v22, v139, v142, s[44:45]
    v_cndmask_b32 v23, v139, v142, s[46:47]
    v_cndmask_b32 v24, v139, v142, s[48:49]
    v_cndmask_b32 v25, v139, v142, s[50:51]
    v_cndmask_b32 v26, v139, v142, s[52:53]
    v_cndmask_b32 v27, v139, v142, s[54:55]
    v_cndmask_b32 v28, v139, v142, s[56:57]
    v_cndmask_b32 v29, v139, v142, s[58:59]
    v_cndmask_b32 v30, v139, v142, s[60:61]
    v_cndmask_b32 v31, v139, v142, s[62:63]
    s_branch sp_dd_26
sp_d8_25:
    v_cndmask_b32 v16, v142, v139, s[32:33]
    v_cndmask_b32 v17, v142, v139, s[34:35]
    v_cndmask_b32 v18, v142, v139, s[36:37]
    v_cndmask_b32 v19, v142, v139, s[38:39]
    v_cndmask_b32 v20, v142, v139, s[40:41]
    v_cndmask_b32 v21, v142, v139, s[42:43]
    v_cndmask_b32 v22, v142, v139, s[44:45]
    v_cndmask_b32 v23, v142, v139, s[46:47]
    v_cndmask_b32 v24, v142, v139, s[48:49]
    v_cndmask_b32 v25, v142, v139, s[50:51]
    v_cndmask_b32 v26, v142, v139, s[52:53]
    v_cndmask_b32 v27, v142, v139, s[54:55]
    v_cndmask_b32 v28, v142, v139, s[56:57]
    v_cndmask_b32 v29, v142, v139, s[58:59]
    v_cndmask_b32 v30, v142, v139, s[60:61]
    v_cndmask_b32 v31, v142, v139, s[62:63]
sp_dd_26:
    s_waitcnt vmcnt(0)
    s_nop 1
    v_mfma_f32_32x32x16_bf16 v[32:47], v[108:111], v[128:131], v[16:31]
    v_mfma_f32_32x32x16_bf16 v[32:47], v[112:115], v[132:135], v[32:47]
    s_nop 15
    v_max3_f32 v143, v143, v32, v33
    v_max3_f32 v143, v143, v34, v35
    v_max3_f32 v143, v143, v36, v37
    v_max3_f32 v143, v143, v38, v39
    v_max3_f32 v143, v143, v40, v41
    v_max3_f32 v143, v143, v42, v43
    v_max3_f32 v143, v143, v44, v45
    v_max3_f32 v143, v143, v46, v47
    s_add_u32 s22, s22, s27
    s_add_u32 s66, s66, 1
    s_cmp_lt_u32 s66, s28
    s_cbranch_scc1 sp_p1_23
    v_mov_b32 v140, v143
    v_mov_b32 v141, v140
    s_nop 1
    v_permlane32_swap_b32 v140, v141
    s_nop 1
    v_max_f32 v140, v140, v141
    v_sub_f32 v142, 0, v140
    v_mov_b32 v152, 0
    v_mov_b32 v153, 0
    v_mov_b32 v154, 0
    v_mov_b32 v155, 0
    v_mov_b32 v156, 0
    v_mov_b32 v157, 0
    v_mov_b32 v158, 0
    v_mov_b32 v159, 0
    v_mov_b32 v160, 0
    v_mov_b32 v161, 0
    v_mov_b32 v162, 0
    v_mov_b32 v163, 0
    v_mov_b32 v164, 0
    v_mov_b32 v165, 0
    v_mov_b32 v166, 0
    v_mov_b32 v167, 0
    v_mov_b32 v168, 0
    v_mov_b32 v169, 0
    v_mov_b32 v170, 0
    v_mov_b32 v171, 0
    s_mov_b32 s66, 0
    s_mov_b32 s22, s26
sp_p2_27:
    buffer_load_dwordx4 v[108:111], v127, s[8:11], s22 offen
    buffer_load_dwordx4 v[112:115], v127, s[8:11], s22 offen offset:1024
    buffer_load_dwordx4 v[116:119], v127, s[8:11], s22 offen offset:2048
    buffer_load_dwordx4 v[120:123], v127, s[8:11], s22 offen offset:3072
    s_cmp_eq_u32 s66, 0
    s_cbranch_scc1 sp_d0_28
    s_cmp_eq_u32 s66, 8
    s_cbranch_scc1 sp_d8_29
    v_mov_b32 v16, v142
    v_mov_b32 v17, v142
    v_mov_b32 v18, v142
    v_mov_b32 v19, v142
    v_mov_b32 v20, v142
    v_mov_b32 v21, v142
    v_mov_b32 v22, v142
    v_mov_b32 v23, v142
    v_mov_b32 v24, v142
    v_mov_b32 v25, v142
    v_mov_b32 v26, v142
    v_mov_b32 v27, v142
    v_mov_b32 v28, v142
    v_mov_b32 v29, v142
    v_mov_b32 v30, v142
    v_mov_b32 v31, v142
    s_branch sp_dd_30
sp_d0_28:
    v_cndmask_b32 v16, v139, v142, s[32:33]
    v_cndmask_b32 v17, v139, v142, s[34:35]
    v_cndmask_b32 v18, v139, v142, s[36:37]
    v_cndmask_b32 v19, v139, v142, s[38:39]
    v_cndmask_b32 v20, v139, v142, s[40:41]
    v_cndmask_b32 v21, v139, v142, s[42:43]
    v_cndmask_b32 v22, v139, v142, s[44:45]
    v_cndmask_b32 v23, v139, v142, s[46:47]
    v_cndmask_b32 v24, v139, v142, s[48:49]
    v_cndmask_b32 v25, v139, v142, s[50:51]
    v_cndmask_b32 v26, v139, v142, s[52:53]
    v_cndmask_b32 v27, v139, v142, s[54:55]
    v_cndmask_b32 v28, v139, v142, s[56:57]
    v_cndmask_b32 v29, v139, v142, s[58:59]
    v_cndmask_b32 v30, v139, v142, s[60:61]
    v_cndmask_b32 v31, v139, v142, s[62:63]
    s_branch sp_dd_30
sp_d8_29:
    v_cndmask_b32 v16, v142, v139, s[32:33]
    v_cndmask_b32 v17, v142, v139, s[34:35]
    v_cndmask_b32 v18, v142, v139, s[36:37]
    v_cndmask_b32 v19, v142, v139, s[38:39]
    v_cndmask_b32 v20, v142, v139, s[40:41]
    v_cndmask_b32 v21, v142, v139, s[42:43]
    v_cndmask_b32 v22, v142, v139, s[44:45]
    v_cndmask_b32 v23, v142, v139, s[46:47]
    v_cndmask_b32 v24, v142, v139, s[48:49]
    v_cndmask_b32 v25, v142, v139, s[50:51]
    v_cndmask_b32 v26, v142, v139, s[52:53]
    v_cndmask_b32 v27, v142, v139, s[54:55]
    v_cndmask_b32 v28, v142, v139, s[56:57]
    v_cndmask_b32 v29, v142, v139, s[58:59]
    v_cndmask_b32 v30, v142, v139, s[60:61]
    v_cndmask_b32 v31, v142, v139, s[62:63]
sp_dd_30:
    s_waitcnt vmcnt(0)
    s_nop 1
    v_mfma_f32_32x32x16_bf16 v[32:47], v[108:111], v[128:131], v[16:31]
    v_mfma_f32_32x32x16_bf16 v[32:47], v[112:115], v[132:135], v[32:47]
    s_nop 15
    v_exp_f32 v32, v32
    v_exp_f32 v33, v33
    v_exp_f32 v34, v34
    v_exp_f32 v35, v35
    v_exp_f32 v36, v36
    v_exp_f32 v37, v37
    v_exp_f32 v38, v38
    v_exp_f32 v39, v39
    v_exp_f32 v40, v40
    v_exp_f32 v41, v41
    v_exp_f32 v42, v42
    v_exp_f32 v43, v43
    v_exp_f32 v44, v44
    v_exp_f32 v45, v45
    v_exp_f32 v46, v46
    v_exp_f32 v47, v47
    s_nop 0
    v_cvt_pk_bf16_f32 v64, v32, v33
    v_cvt_pk_bf16_f32 v65, v34, v35
    v_cvt_pk_bf16_f32 v66, v36, v37
    v_cvt_pk_bf16_f32 v67, v38, v39
    v_cvt_pk_bf16_f32 v68, v40, v41
    v_cvt_pk_bf16_f32 v69, v42, v43
    v_cvt_pk_bf16_f32 v70, v44, v45
    v_cvt_pk_bf16_f32 v71, v46, v47
    s_nop 1
    v_mfma_f32_32x32x16_bf16 v[152:167], v[116:119], v[64:67], v[152:167]
    v_mfma_f32_32x32x16_bf16 v[152:167], v[120:123], v[68:71], v[152:167]
    v_smfmac_f32_16x16x64_bf16 v[168:171], v[100:103], v[64:71], v104
    s_nop 15
    s_add_u32 s22, s22, s27
    s_add_u32 s66, s66, 1
    s_cmp_lt_u32 s66, s28
    s_cbranch_scc1 sp_p2_27
    s_nop 15
    v_add_f32 v140, v168, v169
    s_branch p2_norm_A
p2_end:
    s_endpgm
.globl outp_kernel
.p2align 8
.type outp_kernel,@function
outp_kernel:
    s_cmp_ge_u32 s2, 256
    s_cbranch_scc1 p3_end
    v_lshrrev_b32 v1, 6, v0
    v_and_b32 v0, 63, v0
    v_readfirstlane_b32 s39, v1
    s_cmp_lt_u32 s39, 4
    s_cbranch_scc1 p3_compute
    s_load_dwordx2 s[4:5], s[0:1], 16
    s_load_dwordx2 s[6:7], s[0:1], 56
    s_load_dwordx2 s[12:13], s[0:1], 80
    s_and_b32 s34, s2, 7
    s_lshr_b32 s35, s2, 3
    s_lshr_b32 s38, s34, 2
    s_and_b32 s40, s34, 3
    s_lshl_b32 s40, s40, 2
    s_and_b32 s36, s35, 3
    s_add_u32 s36, s36, s40
    s_lshr_b32 s37, s35, 2
    s_sub_u32 s39, s39, 4
    s_lshl_b32 s40, s36, 2
    s_add_u32 s40, s40, s39
    s_lshl_b32 s40, s40, 16
    v_lshlrev_b32 v8, 4, v0
    v_add_u32 v1, s40, v8
    v_lshrrev_b32 v10, 4, v0
    s_lshl_b32 s40, s39, 4
    v_add_u32 v8, s40, v10
    v_lshlrev_b32 v8, 11, v8
    v_lshrrev_b32 v9, 2, v0
    v_and_b32 v9, 3, v9
    v_xor_b32 v9, v9, v10
    v_lshl_add_u32 v8, v9, 6, v8
    v_and_b32 v9, 3, v0
    v_lshl_add_u32 v8, v9, 4, v8
    s_lshl_b32 s41, s37, 8
    v_add_u32 v2, s41, v8
    v_add_u32 v3, 16384, v2
    s_lshl_b32 s49, s39, 12
    s_add_u32 s50, s49, 16384
    s_mov_b32 s52, 17825792
    s_cmp_eq_u32 s38, 1
    s_cselect_b32 s52, 22020096, s52
    s_mov_b32 s53, 0
    s_mov_b32 s46, 0
    s_mov_b32 s48, 0
    s_mov_b32 s18, 2097152
    s_mov_b32 s19, 0x00020000
    s_mov_b32 s14, 0x2000000
    s_mov_b32 s15, 0x00020000
    s_waitcnt lgkmcnt(0)
    s_cmp_eq_u32 s38, 1
    s_cselect_b32 s16, s6, s4
    s_cselect_b32 s17, s7, s5
p3_lloop:
    s_cmp_lt_u32 s48, 2
    s_cbranch_scc1 p3_lissue
    s_waitcnt vmcnt(8)
    s_barrier
p3_lissue:
    s_add_u32 s57, s46, s50
    s_add_u32 m0, s57, 0
    s_add_u32 s58, s53, 8192
    buffer_load_dwordx4 v2, s[16:19], s53 offen  lds
    s_add_u32 m0, s57, 1024
    s_nop 0
    buffer_load_dwordx4 v2, s[16:19], s58 offen  lds
    s_add_u32 m0, s57, 2048
    s_nop 0
    buffer_load_dwordx4 v3, s[16:19], s53 offen  lds
    s_add_u32 m0, s57, 3072
    s_nop 0
    buffer_load_dwordx4 v3, s[16:19], s58 offen  lds
    s_add_u32 m0, s46, s49
    s_add_u32 s53, s53, 131072
    buffer_load_dwordx4 v1, s[12:15], s52 offen offset:0  lds
    buffer_load_dwordx4 v1, s[12:15], s52 offen offset:1024  lds
    buffer_load_dwordx4 v1, s[12:15], s52 offen offset:2048  lds
    buffer_load_dwordx4 v1, s[12:15], s52 offen offset:3072  lds
    s_add_u32 s52, s52, 4096
    s_add_u32 s46, s46, 32768
    s_cmp_eq_u32 s46, 163840
    s_cselect_b32 s46, 0, s46
    s_add_u32 s48, s48, 1
    s_cmp_lt_u32 s48, 16
    s_cbranch_scc1 p3_lloop
    s_waitcnt vmcnt(8)
    s_barrier
    s_waitcnt vmcnt(0)
    s_barrier
    s_endpgm
p3_compute:
    s_load_dwordx2 s[20:21], s[0:1], 64
    s_and_b32 s34, s2, 7
    s_lshr_b32 s35, s2, 3
    s_lshr_b32 s38, s34, 2
    s_and_b32 s40, s34, 3
    s_lshl_b32 s40, s40, 2
    s_and_b32 s36, s35, 3
    s_add_u32 s36, s36, s40
    s_lshr_b32 s37, s35, 2
    s_mov_b32 s22, 0x800000
    s_mov_b32 s23, 0x00020000
    v_lshrrev_b32 v136, 5, v0
    s_and_b32 s40, s39, 1
    s_lshl_b32 s40, s40, 13
    v_lshlrev_b32 v137, 4, v0
    v_add_u32 v128, s40, v137
    v_lshrrev_b32 v138, 2, v0
    v_and_b32 v138, 3, v138
    v_lshlrev_b32 v139, 2, v136
    v_add_u32 v139, v139, v138
    v_lshlrev_b32 v139, 8, v139
    v_lshrrev_b32 v140, 4, v0
    v_and_b32 v140, 1, v140
    v_lshlrev_b32 v140, 5, v140
    v_add_u32 v139, v139, v140
    v_and_b32 v140, 3, v0
    v_lshlrev_b32 v140, 3, v140
    v_add_u32 v139, v139, v140
    v_add_u32 v139, 16384, v139
    s_and_b32 s40, s39, 2
    s_add_u32 s41, s40, 0
    v_xor_b32 v140, s41, v138
    v_lshlrev_b32 v140, 6, v140
    v_add_u32 v129, v139, v140
    s_add_u32 s41, s40, 1
    v_xor_b32 v140, s41, v138
    v_lshlrev_b32 v140, 6, v140
    v_add_u32 v130, v139, v140
    v_and_b32 v137, 15, v0
    v_lshlrev_b32 v137, 12, v137
    v_lshlrev_b32 v138, 4, v136
    v_add_u32 v131, v137, v138
    v_and_b32 v137, 16, v0
    v_lshl_add_u32 v131, v137, 1, v131
    v_add_u32 v132, 131072, v131
    v_mov_b32 v0, 0
    v_mov_b32 v1, 0
    v_mov_b32 v2, 0
    v_mov_b32 v3, 0
    v_mov_b32 v4, 0
    v_mov_b32 v5, 0
    v_mov_b32 v6, 0
    v_mov_b32 v7, 0
    v_mov_b32 v8, 0
    v_mov_b32 v9, 0
    v_mov_b32 v10, 0
    v_mov_b32 v11, 0
    v_mov_b32 v12, 0
    v_mov_b32 v13, 0
    v_mov_b32 v14, 0
    v_mov_b32 v15, 0
    v_mov_b32 v16, 0
    v_mov_b32 v17, 0
    v_mov_b32 v18, 0
    v_mov_b32 v19, 0
    v_mov_b32 v20, 0
    v_mov_b32 v21, 0
    v_mov_b32 v22, 0
    v_mov_b32 v23, 0
    v_mov_b32 v24, 0
    v_mov_b32 v25, 0
    v_mov_b32 v26, 0
    v_mov_b32 v27, 0
    v_mov_b32 v28, 0
    v_mov_b32 v29, 0
    v_mov_b32 v30, 0
    v_mov_b32 v31, 0
    v_mov_b32 v32, 0
    v_mov_b32 v33, 0
    v_mov_b32 v34, 0
    v_mov_b32 v35, 0
    v_mov_b32 v36, 0
    v_mov_b32 v37, 0
    v_mov_b32 v38, 0
    v_mov_b32 v39, 0
    v_mov_b32 v40, 0
    v_mov_b32 v41, 0
    v_mov_b32 v42, 0
    v_mov_b32 v43, 0
    v_mov_b32 v44, 0
    v_mov_b32 v45, 0
    v_mov_b32 v46, 0
    v_mov_b32 v47, 0
    v_mov_b32 v48, 0
    v_mov_b32 v49, 0
    v_mov_b32 v50, 0
    v_mov_b32 v51, 0
    v_mov_b32 v52, 0
    v_mov_b32 v53, 0
    v_mov_b32 v54, 0
    v_mov_b32 v55, 0
    v_mov_b32 v56, 0
    v_mov_b32 v57, 0
    v_mov_b32 v58, 0
    v_mov_b32 v59, 0
    v_mov_b32 v60, 0
    v_mov_b32 v61, 0
    v_mov_b32 v62, 0
    v_mov_b32 v63, 0
    s_mov_b32 s46, 0
    s_mov_b32 s48, 15
    s_barrier
    ds_read_b64_tr_b16 v[80:81], v129 offset:0
    ds_read_b64_tr_b16 v[82:83], v129 offset:2048
    ds_read_b128 v[64:67], v128 offset:0
    ds_read_b64_tr_b16 v[88:89], v130 offset:0
    ds_read_b64_tr_b16 v[90:91], v130 offset:2048
    ds_read_b128 v[72:75], v128 offset:4096
    ds_read_b64_tr_b16 v[84:85], v129 offset:4096
    ds_read_b64_tr_b16 v[86:87], v129 offset:6144
    ds_read_b128 v[68:71], v128 offset:1024
    ds_read_b64_tr_b16 v[92:93], v130 offset:4096
    ds_read_b64_tr_b16 v[94:95], v130 offset:6144
    ds_read_b128 v[76:79], v128 offset:5120
p3_loop:
    s_waitcnt lgkmcnt(0)
    v_mfma_f32_32x32x16_bf16 v[0:15], v[80:83], v[64:67], v[0:15]
    ds_read_b64_tr_b16 v[112:113], v129 offset:8192
    ds_read_b64_tr_b16 v[114:115], v129 offset:10240
    ds_read_b128 v[96:99], v128 offset:2048
    v_mfma_f32_32x32x16_bf16 v[16:31], v[88:91], v[64:67], v[16:31]
    ds_read_b64_tr_b16 v[120:121], v130 offset:8192
    ds_read_b64_tr_b16 v[122:123], v130 offset:10240
    ds_read_b128 v[104:107], v128 offset:6144
    v_mfma_f32_32x32x16_bf16 v[32:47], v[80:83], v[72:75], v[32:47]
    ds_read_b64_tr_b16 v[116:117], v129 offset:12288
    ds_read_b64_tr_b16 v[118:119], v129 offset:14336
    ds_read_b128 v[100:103], v128 offset:3072
    v_mfma_f32_32x32x16_bf16 v[48:63], v[88:91], v[72:75], v[48:63]
    ds_read_b64_tr_b16 v[124:125], v130 offset:12288
    ds_read_b64_tr_b16 v[126:127], v130 offset:14336
    ds_read_b128 v[108:111], v128 offset:7168
    v_mfma_f32_32x32x16_bf16 v[0:15], v[84:87], v[68:71], v[0:15]
    v_mfma_f32_32x32x16_bf16 v[16:31], v[92:95], v[68:71], v[16:31]
    v_mfma_f32_32x32x16_bf16 v[32:47], v[84:87], v[76:79], v[32:47]
    v_mfma_f32_32x32x16_bf16 v[48:63], v[92:95], v[76:79], v[48:63]
    s_waitcnt lgkmcnt(0)
    v_mfma_f32_32x32x16_bf16 v[0:15], v[112:115], v[96:99], v[0:15]
    s_add_u32 s46, s46, 32768
    s_mov_b32 s47, 32768
    s_cmp_eq_u32 s46, 163840
    s_cselect_b32 s47, 4294836224, s47
    s_cselect_b32 s46, 0, s46
    v_add_u32 v128, s47, v128
    v_add_u32 v129, s47, v129
    v_add_u32 v130, s47, v130
    s_barrier
    ds_read_b64_tr_b16 v[80:81], v129 offset:0
    ds_read_b64_tr_b16 v[82:83], v129 offset:2048
    ds_read_b128 v[64:67], v128 offset:0
    v_mfma_f32_32x32x16_bf16 v[16:31], v[120:123], v[96:99], v[16:31]
    ds_read_b64_tr_b16 v[88:89], v130 offset:0
    ds_read_b64_tr_b16 v[90:91], v130 offset:2048
    ds_read_b128 v[72:75], v128 offset:4096
    v_mfma_f32_32x32x16_bf16 v[32:47], v[112:115], v[104:107], v[32:47]
    ds_read_b64_tr_b16 v[84:85], v129 offset:4096
    ds_read_b64_tr_b16 v[86:87], v129 offset:6144
    ds_read_b128 v[68:71], v128 offset:1024
    v_mfma_f32_32x32x16_bf16 v[48:63], v[120:123], v[104:107], v[48:63]
    ds_read_b64_tr_b16 v[92:93], v130 offset:4096
    ds_read_b64_tr_b16 v[94:95], v130 offset:6144
    ds_read_b128 v[76:79], v128 offset:5120
    v_mfma_f32_32x32x16_bf16 v[0:15], v[116:119], v[100:103], v[0:15]
    v_mfma_f32_32x32x16_bf16 v[16:31], v[124:127], v[100:103], v[16:31]
    v_mfma_f32_32x32x16_bf16 v[32:47], v[116:119], v[108:111], v[32:47]
    v_mfma_f32_32x32x16_bf16 v[48:63], v[124:127], v[108:111], v[48:63]
    s_sub_u32 s48, s48, 1
    s_cmp_lg_u32 s48, 0
    s_cbranch_scc1 p3_loop
    s_waitcnt lgkmcnt(0)
    v_mfma_f32_32x32x16_bf16 v[0:15], v[80:83], v[64:67], v[0:15]
    ds_read_b64_tr_b16 v[112:113], v129 offset:8192
    ds_read_b64_tr_b16 v[114:115], v129 offset:10240
    ds_read_b128 v[96:99], v128 offset:2048
    v_mfma_f32_32x32x16_bf16 v[0:15], v[84:87], v[68:71], v[0:15]
    ds_read_b64_tr_b16 v[116:117], v129 offset:12288
    ds_read_b64_tr_b16 v[118:119], v129 offset:14336
    ds_read_b128 v[100:103], v128 offset:3072
    v_mfma_f32_32x32x16_bf16 v[16:31], v[88:91], v[64:67], v[16:31]
    ds_read_b64_tr_b16 v[120:121], v130 offset:8192
    ds_read_b64_tr_b16 v[122:123], v130 offset:10240
    ds_read_b64_tr_b16 v[124:125], v130 offset:12288
    ds_read_b64_tr_b16 v[126:127], v130 offset:14336
    v_mfma_f32_32x32x16_bf16 v[16:31], v[92:95], v[68:71], v[16:31]
    ds_read_b128 v[104:107], v128 offset:6144
    ds_read_b128 v[108:111], v128 offset:7168
    s_waitcnt lgkmcnt(6)
    v_mfma_f32_32x32x16_bf16 v[0:15], v[112:115], v[96:99], v[0:15]
    v_mfma_f32_32x32x16_bf16 v[0:15], v[116:119], v[100:103], v[0:15]
    s_waitcnt lgkmcnt(2)
    v_mfma_f32_32x32x16_bf16 v[16:31], v[120:123], v[96:99], v[16:31]
    s_lshl_b32 s40, s36, 19
    s_and_b32 s41, s39, 1
    s_lshl_b32 s41, s41, 18
    s_add_u32 s40, s40, s41
    s_lshl_b32 s41, s38, 11
    s_add_u32 s40, s40, s41
    v_mfma_f32_32x32x16_bf16 v[16:31], v[124:127], v[100:103], v[16:31]
    s_lshl_b32 s41, s37, 8
    s_add_u32 s40, s40, s41
    s_and_b32 s41, s39, 2
    s_lshl_b32 s41, s41, 6
    s_add_u32 s40, s40, s41
    s_add_u32 s41, s40, 65536
    v_mfma_f32_32x32x16_bf16 v[32:47], v[80:83], v[72:75], v[32:47]
    v_cvt_pk_bf16_f32 v0, v0, v1
    v_cvt_pk_bf16_f32 v1, v2, v3
    v_cvt_pk_bf16_f32 v2, v4, v5
    v_cvt_pk_bf16_f32 v3, v6, v7
    v_mfma_f32_32x32x16_bf16 v[32:47], v[84:87], v[76:79], v[32:47]
    v_cvt_pk_bf16_f32 v4, v8, v9
    v_cvt_pk_bf16_f32 v5, v10, v11
    v_cvt_pk_bf16_f32 v6, v12, v13
    v_cvt_pk_bf16_f32 v7, v14, v15
    s_waitcnt lgkmcnt(0)
    v_mfma_f32_32x32x16_bf16 v[32:47], v[112:115], v[104:107], v[32:47]
    v_permlane32_swap_b32 v0, v2
    v_permlane32_swap_b32 v1, v3
    v_permlane32_swap_b32 v4, v6
    v_permlane32_swap_b32 v5, v7
    v_mfma_f32_32x32x16_bf16 v[32:47], v[116:119], v[108:111], v[32:47]
    s_nop 0
    v_permlane16_swap_b32 v0, v4
    v_permlane16_swap_b32 v1, v5
    v_permlane16_swap_b32 v2, v6
    v_permlane16_swap_b32 v3, v7
    v_mfma_f32_32x32x16_bf16 v[48:63], v[88:91], v[72:75], v[48:63]
    s_nop 0
    buffer_store_dwordx4 v[0:3], v131, s[20:23], s40 offen offset:0 sc1
    buffer_store_dwordx4 v[4:7], v131, s[20:23], s41 offen offset:0 sc1
    v_cvt_pk_bf16_f32 v16, v16, v17
    v_cvt_pk_bf16_f32 v17, v18, v19
    v_cvt_pk_bf16_f32 v18, v20, v21
    v_cvt_pk_bf16_f32 v19, v22, v23
    v_mfma_f32_32x32x16_bf16 v[48:63], v[92:95], v[76:79], v[48:63]
    v_cvt_pk_bf16_f32 v20, v24, v25
    v_cvt_pk_bf16_f32 v21, v26, v27
    v_cvt_pk_bf16_f32 v22, v28, v29
    v_cvt_pk_bf16_f32 v23, v30, v31
    v_mfma_f32_32x32x16_bf16 v[48:63], v[120:123], v[104:107], v[48:63]
    s_nop 0
    v_permlane32_swap_b32 v16, v18
    v_permlane32_swap_b32 v17, v19
    v_permlane32_swap_b32 v20, v22
    v_permlane32_swap_b32 v21, v23
    v_mfma_f32_32x32x16_bf16 v[48:63], v[124:127], v[108:111], v[48:63]
    s_nop 0
    v_permlane16_swap_b32 v16, v20
    v_permlane16_swap_b32 v17, v21
    v_permlane16_swap_b32 v18, v22
    v_permlane16_swap_b32 v19, v23
    s_nop 1
    buffer_store_dwordx4 v[16:19], v131, s[20:23], s40 offen offset:64 sc1
    buffer_store_dwordx4 v[20:23], v131, s[20:23], s41 offen offset:64 sc1
    v_cvt_pk_bf16_f32 v32, v32, v33
    v_cvt_pk_bf16_f32 v33, v34, v35
    v_cvt_pk_bf16_f32 v34, v36, v37
    v_cvt_pk_bf16_f32 v35, v38, v39
    v_cvt_pk_bf16_f32 v36, v40, v41
    v_cvt_pk_bf16_f32 v37, v42, v43
    v_cvt_pk_bf16_f32 v38, v44, v45
    v_cvt_pk_bf16_f32 v39, v46, v47
    s_nop 1
    v_permlane32_swap_b32 v32, v34
    v_permlane32_swap_b32 v33, v35
    v_permlane32_swap_b32 v36, v38
    v_permlane32_swap_b32 v37, v39
    s_nop 1
    v_permlane16_swap_b32 v32, v36
    v_permlane16_swap_b32 v33, v37
    v_permlane16_swap_b32 v34, v38
    v_permlane16_swap_b32 v35, v39
    s_nop 1
    buffer_store_dwordx4 v[32:35], v132, s[20:23], s40 offen offset:0 sc1
    buffer_store_dwordx4 v[36:39], v132, s[20:23], s41 offen offset:0 sc1
    v_cvt_pk_bf16_f32 v48, v48, v49
    v_cvt_pk_bf16_f32 v49, v50, v51
    v_cvt_pk_bf16_f32 v50, v52, v53
    v_cvt_pk_bf16_f32 v51, v54, v55
    v_cvt_pk_bf16_f32 v52, v56, v57
    v_cvt_pk_bf16_f32 v53, v58, v59
    v_cvt_pk_bf16_f32 v54, v60, v61
    v_cvt_pk_bf16_f32 v55, v62, v63
    s_nop 1
    v_permlane32_swap_b32 v48, v50
    v_permlane32_swap_b32 v49, v51
    v_permlane32_swap_b32 v52, v54
    v_permlane32_swap_b32 v53, v55
    s_nop 1
    v_permlane16_swap_b32 v48, v52
    v_permlane16_swap_b32 v49, v53
    v_permlane16_swap_b32 v50, v54
    v_permlane16_swap_b32 v51, v55
    s_nop 1
    buffer_store_dwordx4 v[48:51], v132, s[20:23], s40 offen offset:64 sc1
    buffer_store_dwordx4 v[52:55], v132, s[20:23], s41 offen offset:64 sc1
    s_endpgm
p3_end:
    s_endpgm
.section .rodata,"a"
.p2align 6
.amdhsa_kernel proj_kernel
  .amdhsa_next_free_vgpr 256
  .amdhsa_next_free_sgpr 102
  .amdhsa_accum_offset 256
  .amdhsa_group_segment_fixed_size 0
  .amdhsa_kernarg_size 88
  .amdhsa_user_sgpr_count 2
  .amdhsa_user_sgpr_kernarg_segment_ptr 1
  .amdhsa_system_sgpr_workgroup_id_x 1
.end_amdhsa_kernel
.section .rodata,"a"
.p2align 6
.amdhsa_kernel attn_kernel
  .amdhsa_next_free_vgpr 176
  .amdhsa_next_free_sgpr 102
  .amdhsa_accum_offset 176
  .amdhsa_group_segment_fixed_size 0
  .amdhsa_kernarg_size 88
  .amdhsa_user_sgpr_count 2
  .amdhsa_user_sgpr_kernarg_segment_ptr 1
  .amdhsa_system_sgpr_workgroup_id_x 1
.end_amdhsa_kernel
.section .rodata,"a"
.p2align 6
.amdhsa_kernel outp_kernel
  .amdhsa_next_free_vgpr 144
  .amdhsa_next_free_sgpr 102
  .amdhsa_accum_offset 144
  .amdhsa_group_segment_fixed_size 0
  .amdhsa_kernarg_size 88
  .amdhsa_user_sgpr_count 2
  .amdhsa_user_sgpr_kernarg_segment_ptr 1
  .amdhsa_system_sgpr_workgroup_id_x 1
.end_amdhsa_kernel
```
